```python
import torch

def _softmax(x, axis=-1):
    return torch.softmax(x, dim=axis)
def _gelu(x):
    return torch.nn.functional.gelu(x, approximate="tanh")
def _silu(x):
    return torch.nn.functional.silu(x)
def _sigmoid(x):
    return torch.sigmoid(x)
def _layernorm(x, axis=-1, eps=1e-5):
    m = x.mean(dim=axis, keepdim=True)
    v = x.var(dim=axis, keepdim=True, unbiased=False)
    return (x - m) / torch.sqrt(v + eps)
def _scatter_add(tgt, idx, src, axis=0):
    return tgt.clone().index_add_(axis, idx, src)
def _segment_sum(src, seg, n):
    out = torch.zeros((n,) + src.shape[1:], dtype=src.dtype)
    return out.index_add_(0, seg, src)
def _pad(x, pw):
    flat = tuple(v for pair in reversed(pw) for v in pair)
    return torch.nn.functional.pad(x, flat)

kernel_name = 'interleave_layers__ssm_conv_h3__linear_kernel_hedgehog__prompt'

def setup_inputs():

    _w = (lambda a: (lambda t: t.to(torch.bfloat16) if t.is_floating_point() else t)(torch.as_tensor(a)))
    def _A_setup():
        B, S, D = 1, 2048, 512
        ks = 4
        return {
            "q": _w((lambda *s: torch.randn(*s, dtype=torch.bfloat16) * 0.05)(B, S, D)),
            "k": _w((lambda *s: torch.randn(*s, dtype=torch.bfloat16) * 0.8)(B, S, D)),
            "v": _w((lambda *s: torch.randn(*s, dtype=torch.bfloat16) * 0.8)(B, S, D)),
            "shift_k": _w((lambda *s: torch.randn(*s, dtype=torch.bfloat16) * 0.8)(D, ks) * 0.5),
            "ssm_k": _w((lambda *s: torch.randn(*s, dtype=torch.bfloat16) * 0.8)(D, S) * (1.0 / S ** 0.5)),
            "ssm_D": _w((lambda *s: torch.randn(*s, dtype=torch.bfloat16) * 0.8)(D)),
        }
    _A_in = _A_setup()

    def _B_setup():
        B, S, D, H = 1, 2048, 512, 32
        Dh = D // H
        return {
            "x": _w((lambda *s: torch.randn(*s, dtype=torch.bfloat16) * 0.05)(B, S, D)),
            "wqkv": _w((lambda *s: torch.randn(*s, dtype=torch.bfloat16) * 0.4)(D, 3 * D)),
            "w_phi": _w((lambda *s: torch.randn(*s, dtype=torch.bfloat16) * 0.4)(H, Dh, Dh) * (Dh ** -0.5)),
            "wo": _w((lambda *s: torch.randn(*s, dtype=torch.bfloat16) * 0.2)(D, D)),
        }
    _B_in = _B_setup()

    return {
        "A_q": _A_in["q"],
        "A_k": _A_in["k"],
        "A_v": _A_in["v"],
        "A_shift_k": _A_in["shift_k"],
        "A_ssm_k": _A_in["ssm_k"],
        "A_ssm_D": _A_in["ssm_D"],
        "B_x": _B_in["x"],
        "B_wqkv": _B_in["wqkv"],
        "B_w_phi": _B_in["w_phi"],
        "B_wo": _B_in["wo"],
    }

def reference(A_q, A_k, A_v, A_shift_k, A_ssm_k, A_ssm_D, B_x, B_wqkv, B_w_phi, B_wo):
    def _A_ref(q, k, v, shift_k, ssm_k, ssm_D):
        B, S, D = q.shape
        ks = shift_k.shape[-1]
        k_pad = _pad(k, ((0, 0), (ks - 1, 0), (0, 0)))
        k_shift = torch.zeros_like(k)
        for t in range(ks):
            k_shift = k_shift + k_pad[:, t:t + S, :] * shift_k[:, ks - 1 - t][None, None, :]
        kv = k_shift * v
        L = 2 * S
        kv_pad = _pad(kv, ((0, 0), (0, S), (0, 0)))
        kf_pad = _pad(ssm_k, ((0, 0), (0, S)))
        kv_f = (lambda x, axes=(-2,-1): torch.fft.rfft2(x.float(), dim=axes))(kv_pad[:, None, :, :], axes=(1, 2))
        kf_f = (lambda x, axes=(-2,-1): torch.fft.rfft2(x.float(), dim=axes))(kf_pad[:, None, :], axes=(1, 2))
        kf_f = (lambda x, *d: x.permute(*d))(kf_f, 1, 2, 0)
        y_f = kv_f * kf_f[None, :, :, :]
        y = (lambda x, s, axes=(-2,-1): torch.fft.irfft2(x, s=s, dim=axes).to(torch.bfloat16))(y_f, (1, L), axes=(1, 2))[:, 0, :S, :]
        y = y + kv * ssm_D[None, None, :]
        return q * y

    def _B_ref(x, wqkv, w_phi, wo):
        B, S, D = x.shape
        H = 32; Dh = D // H
        qkv = (lambda x, *d: x.permute(*d))((x @ wqkv).reshape(B, S, 3, H, Dh), 2, 0, 3, 1, 4)
        q, k, v = qkv[0], qkv[1], qkv[2]
        pq = torch.einsum("bhsd,hdf->bhsf", q, w_phi)
        pk = torch.einsum("bhsd,hdf->bhsf", k, w_phi)
        phi_q = torch.concatenate([_softmax(pq, axis=-1), _softmax(-pq, axis=-1)], axis=-1)
        phi_k = torch.concatenate([_softmax(pk, axis=-1), _softmax(-pk, axis=-1)], axis=-1)
        kv = torch.einsum("bhsf,bhsd->bhfd", phi_k, v)
        z  = torch.einsum("bhsf->bhf", phi_k)
        num = torch.einsum("bhqf,bhfd->bhqd", phi_q, kv)
        den = torch.einsum("bhqf,bhf->bhq", phi_q, z)[..., None] + 1e-6
        o = num / den
        return (lambda x, *d: x.permute(*d))(o, 0, 2, 1, 3).reshape(B, S, D) @ wo

    x = A_q
    x = x + _A_ref(_layernorm(x, axis=-1), A_k, A_v, A_shift_k, A_ssm_k, A_ssm_D)
    x = x + _B_ref(_layernorm(x, axis=-1), B_wqkv, B_w_phi, B_wo)
    x = x + _A_ref(_layernorm(x, axis=-1), A_k, A_v, A_shift_k, A_ssm_k, A_ssm_D)
    x = x + _B_ref(_layernorm(x, axis=-1), B_wqkv, B_w_phi, B_wo)
    return x
```

```asm
; @launch kernel=interleave_layers__ssm_conv_h3__linear_kernel_hedgehog__prompt_kernel grid=(384,1,1) block=(256,1,1) lds=16384
; @launch kernel=conv_kernel grid=(256,1,1) block=(256,1,1) lds=58880
; @launch kernel=qkv1_kernel grid=(256,1,1) block=(384,1,1) lds=144384
; @launch kernel=proj1_kernel grid=(256,1,1) block=(256,1,1) lds=112640
; @launch kernel=qkv2_kernel grid=(256,1,1) block=(384,1,1) lds=144384
; @launch kernel=proj2_kernel grid=(256,1,1) block=(256,1,1) lds=112640
.amdgcn_target "amdgcn-amd-amdhsa--gfx950"
.text
.globl interleave_layers__ssm_conv_h3__linear_kernel_hedgehog__prompt_kernel
.p2align 8
.type interleave_layers__ssm_conv_h3__linear_kernel_hedgehog__prompt_kernel,@function
interleave_layers__ssm_conv_h3__linear_kernel_hedgehog__prompt_kernel:
    s_cmp_ge_u32 s2, 384
    s_cbranch_scc1 K1_DONE
    s_load_dwordx4 s[4:7], s[0:1], 0
    s_load_dwordx4 s[8:11], s[0:1], 16
    s_load_dwordx4 s[12:15], s[0:1], 56
    s_load_dwordx2 s[16:17], s[0:1], 72
    s_load_dwordx2 s[18:19], s[0:1], 96
    s_load_dwordx4 s[56:59], s[0:1], 32
    s_waitcnt lgkmcnt(0)
    s_mov_b32 s20, s18
    s_mov_b32 s21, s19
    s_mov_b32 s22, 33554432
    s_mov_b32 s23, 0x20000
    s_cmp_ge_u32 s2, 320
    s_cbranch_scc1 K1_PACK
    s_cmp_ge_u32 s2, 256
    s_cbranch_scc1 K1_STATS
    s_mov_b32 s24, s4
    s_mov_b32 s25, s5
    s_mov_b32 s26, 2097152
    s_mov_b32 s27, 0x20000
    s_mov_b32 s28, s6
    s_mov_b32 s29, s7
    s_mov_b32 s30, 2097152
    s_mov_b32 s31, 0x20000
    s_mov_b32 s32, s8
    s_mov_b32 s33, s9
    s_mov_b32 s34, 2097152
    s_mov_b32 s35, 0x20000
    s_mov_b32 s36, s10
    s_mov_b32 s37, s11
    s_mov_b32 s38, 4096
    s_mov_b32 s39, 0x20000
    s_and_b32 s40, s2, 7
    s_lshr_b32 s41, s2, 3
    v_and_b32 v1, 7, v0
    v_lshrrev_b32 v2, 3, v0
    s_lshl_b32 s42, s41, 16
    s_lshl_b32 s43, s40, 7
    s_add_u32 s42, s42, s43
    v_lshlrev_b32 v3, 11, v2
    v_lshl_add_u32 v3, v1, 4, v3
    v_add_u32 v3, s42, v3
    v_add_u32 v4, 0xfffff400, v3
    v_add_u32 v5, 0xfffff800, v3
    v_add_u32 v6, 0xfffffc00, v3
    buffer_load_dwordx4 v[8:11], v4, s[28:31], 0 offen
    buffer_load_dwordx4 v[12:15], v5, s[28:31], 0 offen
    buffer_load_dwordx4 v[16:19], v6, s[28:31], 0 offen
    buffer_load_dwordx4 v[20:23], v3, s[28:31], 0 offen
    buffer_load_dwordx4 v[24:27], v3, s[28:31], 0 offen offset:1024
    s_lshl_b32 s43, s40, 9
    v_lshlrev_b32 v7, 6, v1
    v_add_u32 v7, s43, v7
    buffer_load_dwordx4 v[44:47], v7, s[36:39], 0 offen offset:0
    buffer_load_dwordx4 v[48:51], v7, s[36:39], 0 offen offset:16
    buffer_load_dwordx4 v[52:55], v7, s[36:39], 0 offen offset:32
    buffer_load_dwordx4 v[56:59], v7, s[36:39], 0 offen offset:48
    buffer_load_dwordx4 v[28:31], v3, s[32:35], 0 offen
    buffer_load_dwordx4 v[32:35], v3, s[32:35], 0 offen offset:1024
    buffer_load_dwordx4 v[36:39], v3, s[24:27], 0 offen
    buffer_load_dwordx4 v[40:43], v3, s[24:27], 0 offen offset:1024
    v_lshlrev_b32 v60, 2, v1
    v_sub_u32 v61, 31, v2
    v_xor_b32 v61, v61, v60
    v_xor_b32 v62, v2, v60
    v_lshlrev_b32 v60, 10, v1
    v_lshl_add_u32 v61, v61, 2, v60
    v_lshl_add_u32 v62, v62, 2, v60
    s_mov_b32 s44, 0xffff0000
    s_mov_b32 s45, 0x05040100
    s_mov_b32 s46, 0x07060302
    s_mov_b32 s60, s56
    s_mov_b32 s61, s57
    s_mov_b32 s62, 2097152
    s_mov_b32 s63, 0x20000
    s_lshl_b32 s50, s40, 18
    s_lshl_b32 s51, s41, 13
    s_add_u32 s50, s50, s51
    v_lshlrev_b32 v100, 4, v0
    s_load_dword s51, s[58:59], 0
    buffer_load_dwordx4 v[104:107], v100, s[60:63], s50 offen
    s_add_u32 s50, s50, 4096
    buffer_load_dwordx4 v[104:107], v100, s[60:63], s50 offen
    s_waitcnt vmcnt(4)
    v_lshlrev_b32 v64, 16, v8
    v_lshlrev_b32 v65, 16, v12
    v_lshlrev_b32 v66, 16, v16
    v_lshlrev_b32 v67, 16, v20
    v_lshlrev_b32 v68, 16, v24
    v_lshlrev_b32 v70, 16, v44
    v_and_b32 v71, s44, v44
    v_lshlrev_b32 v72, 16, v45
    v_and_b32 v73, s44, v45
    v_lshlrev_b32 v74, 16, v28
    v_lshlrev_b32 v75, 16, v32
    v_mul_f32 v76, v73, v64
    v_mul_f32 v77, v73, v65
    v_fmac_f32 v76, v72, v65
    v_fmac_f32 v77, v72, v66
    v_fmac_f32 v76, v71, v66
    v_fmac_f32 v77, v71, v67
    v_fmac_f32 v76, v70, v67
    v_fmac_f32 v77, v70, v68
    v_mul_f32 v76, v76, v74
    v_mul_f32 v77, v77, v75
    v_cvt_pk_bf16_f32 v78, v77, v76
    ds_write_b32 v61, v78 offset:0
    v_and_b32 v64, s44, v8
    v_and_b32 v65, s44, v12
    v_and_b32 v66, s44, v16
    v_and_b32 v67, s44, v20
    v_and_b32 v68, s44, v24
    v_lshlrev_b32 v70, 16, v46
    v_and_b32 v71, s44, v46
    v_lshlrev_b32 v72, 16, v47
    v_and_b32 v73, s44, v47
    v_and_b32 v74, s44, v28
    v_and_b32 v75, s44, v32
    v_mul_f32 v76, v73, v64
    v_mul_f32 v77, v73, v65
    v_fmac_f32 v76, v72, v65
    v_fmac_f32 v77, v72, v66
    v_fmac_f32 v76, v71, v66
    v_fmac_f32 v77, v71, v67
    v_fmac_f32 v76, v70, v67
    v_fmac_f32 v77, v70, v68
    v_mul_f32 v76, v76, v74
    v_mul_f32 v77, v77, v75
    v_cvt_pk_bf16_f32 v78, v77, v76
    ds_write_b32 v61, v78 offset:128
    v_lshlrev_b32 v64, 16, v9
    v_lshlrev_b32 v65, 16, v13
    v_lshlrev_b32 v66, 16, v17
    v_lshlrev_b32 v67, 16, v21
    v_lshlrev_b32 v68, 16, v25
    v_lshlrev_b32 v70, 16, v48
    v_and_b32 v71, s44, v48
    v_lshlrev_b32 v72, 16, v49
    v_and_b32 v73, s44, v49
    v_lshlrev_b32 v74, 16, v29
    v_lshlrev_b32 v75, 16, v33
    v_mul_f32 v76, v73, v64
    v_mul_f32 v77, v73, v65
    v_fmac_f32 v76, v72, v65
    v_fmac_f32 v77, v72, v66
    v_fmac_f32 v76, v71, v66
    v_fmac_f32 v77, v71, v67
    v_fmac_f32 v76, v70, v67
    v_fmac_f32 v77, v70, v68
    v_mul_f32 v76, v76, v74
    v_mul_f32 v77, v77, v75
    v_cvt_pk_bf16_f32 v78, v77, v76
    ds_write_b32 v61, v78 offset:256
    v_and_b32 v64, s44, v9
    v_and_b32 v65, s44, v13
    v_and_b32 v66, s44, v17
    v_and_b32 v67, s44, v21
    v_and_b32 v68, s44, v25
    v_lshlrev_b32 v70, 16, v50
    v_and_b32 v71, s44, v50
    v_lshlrev_b32 v72, 16, v51
    v_and_b32 v73, s44, v51
    v_and_b32 v74, s44, v29
    v_and_b32 v75, s44, v33
    v_mul_f32 v76, v73, v64
    v_mul_f32 v77, v73, v65
    v_fmac_f32 v76, v72, v65
    v_fmac_f32 v77, v72, v66
    v_fmac_f32 v76, v71, v66
    v_fmac_f32 v77, v71, v67
    v_fmac_f32 v76, v70, v67
    v_fmac_f32 v77, v70, v68
    v_mul_f32 v76, v76, v74
    v_mul_f32 v77, v77, v75
    v_cvt_pk_bf16_f32 v78, v77, v76
    ds_write_b32 v61, v78 offset:384
    v_lshlrev_b32 v64, 16, v10
    v_lshlrev_b32 v65, 16, v14
    v_lshlrev_b32 v66, 16, v18
    v_lshlrev_b32 v67, 16, v22
    v_lshlrev_b32 v68, 16, v26
    v_lshlrev_b32 v70, 16, v52
    v_and_b32 v71, s44, v52
    v_lshlrev_b32 v72, 16, v53
    v_and_b32 v73, s44, v53
    v_lshlrev_b32 v74, 16, v30
    v_lshlrev_b32 v75, 16, v34
    v_mul_f32 v76, v73, v64
    v_mul_f32 v77, v73, v65
    v_fmac_f32 v76, v72, v65
    v_fmac_f32 v77, v72, v66
    v_fmac_f32 v76, v71, v66
    v_fmac_f32 v77, v71, v67
    v_fmac_f32 v76, v70, v67
    v_fmac_f32 v77, v70, v68
    v_mul_f32 v76, v76, v74
    v_mul_f32 v77, v77, v75
    v_cvt_pk_bf16_f32 v78, v77, v76
    ds_write_b32 v61, v78 offset:512
    v_and_b32 v64, s44, v10
    v_and_b32 v65, s44, v14
    v_and_b32 v66, s44, v18
    v_and_b32 v67, s44, v22
    v_and_b32 v68, s44, v26
    v_lshlrev_b32 v70, 16, v54
    v_and_b32 v71, s44, v54
    v_lshlrev_b32 v72, 16, v55
    v_and_b32 v73, s44, v55
    v_and_b32 v74, s44, v30
    v_and_b32 v75, s44, v34
    v_mul_f32 v76, v73, v64
    v_mul_f32 v77, v73, v65
    v_fmac_f32 v76, v72, v65
    v_fmac_f32 v77, v72, v66
    v_fmac_f32 v76, v71, v66
    v_fmac_f32 v77, v71, v67
    v_fmac_f32 v76, v70, v67
    v_fmac_f32 v77, v70, v68
    v_mul_f32 v76, v76, v74
    v_mul_f32 v77, v77, v75
    v_cvt_pk_bf16_f32 v78, v77, v76
    ds_write_b32 v61, v78 offset:640
    v_lshlrev_b32 v64, 16, v11
    v_lshlrev_b32 v65, 16, v15
    v_lshlrev_b32 v66, 16, v19
    v_lshlrev_b32 v67, 16, v23
    v_lshlrev_b32 v68, 16, v27
    v_lshlrev_b32 v70, 16, v56
    v_and_b32 v71, s44, v56
    v_lshlrev_b32 v72, 16, v57
    v_and_b32 v73, s44, v57
    v_lshlrev_b32 v74, 16, v31
    v_lshlrev_b32 v75, 16, v35
    v_mul_f32 v76, v73, v64
    v_mul_f32 v77, v73, v65
    v_fmac_f32 v76, v72, v65
    v_fmac_f32 v77, v72, v66
    v_fmac_f32 v76, v71, v66
    v_fmac_f32 v77, v71, v67
    v_fmac_f32 v76, v70, v67
    v_fmac_f32 v77, v70, v68
    v_mul_f32 v76, v76, v74
    v_mul_f32 v77, v77, v75
    v_cvt_pk_bf16_f32 v78, v77, v76
    ds_write_b32 v61, v78 offset:768
    v_and_b32 v64, s44, v11
    v_and_b32 v65, s44, v15
    v_and_b32 v66, s44, v19
    v_and_b32 v67, s44, v23
    v_and_b32 v68, s44, v27
    v_lshlrev_b32 v70, 16, v58
    v_and_b32 v71, s44, v58
    v_lshlrev_b32 v72, 16, v59
    v_and_b32 v73, s44, v59
    v_and_b32 v74, s44, v31
    v_and_b32 v75, s44, v35
    v_mul_f32 v76, v73, v64
    v_mul_f32 v77, v73, v65
    v_fmac_f32 v76, v72, v65
    v_fmac_f32 v77, v72, v66
    v_fmac_f32 v76, v71, v66
    v_fmac_f32 v77, v71, v67
    v_fmac_f32 v76, v70, v67
    v_fmac_f32 v77, v70, v68
    v_mul_f32 v76, v76, v74
    v_mul_f32 v77, v77, v75
    v_cvt_pk_bf16_f32 v78, v77, v76
    ds_write_b32 v61, v78 offset:896
    s_waitcnt vmcnt(2)
    v_perm_b32 v64, v40, v36, s45
    ds_write_b32 v62, v64 offset:8192
    v_perm_b32 v65, v40, v36, s46
    ds_write_b32 v62, v65 offset:8320
    v_perm_b32 v66, v41, v37, s45
    ds_write_b32 v62, v66 offset:8448
    v_perm_b32 v67, v41, v37, s46
    ds_write_b32 v62, v67 offset:8576
    v_perm_b32 v68, v42, v38, s45
    ds_write_b32 v62, v68 offset:8704
    v_perm_b32 v69, v42, v38, s46
    ds_write_b32 v62, v69 offset:8832
    v_perm_b32 v70, v43, v39, s45
    ds_write_b32 v62, v70 offset:8960
    v_perm_b32 v71, v43, v39, s46
    ds_write_b32 v62, v71 offset:9088
    v_lshrrev_b32 v4, 6, v0
    v_xor_b32 v5, v1, v4
    v_lshlrev_b32 v6, 7, v2
    v_lshl_add_u32 v5, v5, 4, v6
    v_xor_b32 v6, 64, v5
    s_lshl_b32 s43, s40, 18
    s_lshl_b32 s42, s41, 7
    v_lshlrev_b32 v7, 12, v2
    v_lshl_add_u32 v7, v1, 4, v7
    v_add_u32 v7, s43, v7
    v_add_u32 v8, 0x20000, v7
    s_sub_u32 s47, 3968, s42
    s_add_u32 s48, s42, 2097152
    s_waitcnt lgkmcnt(0)
    s_barrier
    ds_read_b128 v[12:15], v5
    ds_read_b128 v[16:19], v6 offset:4096
    ds_read_b128 v[20:23], v5 offset:8192
    ds_read_b128 v[24:27], v6 offset:12288
    s_waitcnt lgkmcnt(3)
    buffer_store_dwordx4 v[12:15], v7, s[20:23], s47 offen sc1
    s_waitcnt lgkmcnt(2)
    buffer_store_dwordx4 v[16:19], v8, s[20:23], s47 offen sc1
    s_waitcnt lgkmcnt(1)
    buffer_store_dwordx4 v[20:23], v7, s[20:23], s48 offen sc1
    s_waitcnt lgkmcnt(0)
    buffer_store_dwordx4 v[24:27], v8, s[20:23], s48 offen sc1
    s_waitcnt vmcnt(4)
    s_endpgm
K1_STATS:
    s_mov_b32 s24, s4
    s_mov_b32 s25, s5
    s_mov_b32 s26, 2097152
    s_mov_b32 s27, 0x20000
    s_sub_u32 s40, s2, 256
    v_lshrrev_b32 v1, 3, v0
    v_and_b32 v2, 7, v0
    s_lshl_b32 s41, s40, 15
    v_lshlrev_b32 v3, 10, v1
    v_lshl_add_u32 v3, v2, 4, v3
    buffer_load_dwordx4 v[8:11], v3, s[24:27], s41 offen offset:0
    buffer_load_dwordx4 v[12:15], v3, s[24:27], s41 offen offset:128
    buffer_load_dwordx4 v[16:19], v3, s[24:27], s41 offen offset:256
    buffer_load_dwordx4 v[20:23], v3, s[24:27], s41 offen offset:384
    buffer_load_dwordx4 v[24:27], v3, s[24:27], s41 offen offset:512
    buffer_load_dwordx4 v[28:31], v3, s[24:27], s41 offen offset:640
    buffer_load_dwordx4 v[32:35], v3, s[24:27], s41 offen offset:768
    buffer_load_dwordx4 v[36:39], v3, s[24:27], s41 offen offset:896
    s_lshl_b32 s42, s40, 12
    s_add_u32 s42, s42, 25165824
    s_lshl_b32 s43, s40, 10
    s_add_u32 s43, s43, 26214400
    v_mov_b32 v44, 0
    v_mov_b32 v45, 0
    v_mov_b32 v46, 0
    v_mov_b32 v47, 0
    v_mov_b32 v48, -1
    v_lshlrev_b32 v4, 4, v0
    v_lshlrev_b32 v5, 2, v0
    v_and_b32 v6, 63, v0
    v_lshlrev_b32 v6, 19, v6
    buffer_load_dword v53, v6, s[20:23], 0 offen
    buffer_store_dwordx4 v[44:47], v4, s[20:23], s42 offen sc1
    buffer_store_dword v48, v5, s[20:23], s43 offen sc1
    v_mov_b32 v50, 0
    v_mov_b32 v51, 0
    v_mov_b32 v52, 0x3f803f80
    s_waitcnt vmcnt(3)
    v_dot2_f32_bf16 v50, v8, v52, v50
    v_dot2_f32_bf16 v51, v8, v8, v51
    v_dot2_f32_bf16 v50, v9, v52, v50
    v_dot2_f32_bf16 v51, v9, v9, v51
    v_dot2_f32_bf16 v50, v10, v52, v50
    v_dot2_f32_bf16 v51, v10, v10, v51
    v_dot2_f32_bf16 v50, v11, v52, v50
    v_dot2_f32_bf16 v51, v11, v11, v51
    v_dot2_f32_bf16 v50, v12, v52, v50
    v_dot2_f32_bf16 v51, v12, v12, v51
    v_dot2_f32_bf16 v50, v13, v52, v50
    v_dot2_f32_bf16 v51, v13, v13, v51
    v_dot2_f32_bf16 v50, v14, v52, v50
    v_dot2_f32_bf16 v51, v14, v14, v51
    v_dot2_f32_bf16 v50, v15, v52, v50
    v_dot2_f32_bf16 v51, v15, v15, v51
    v_dot2_f32_bf16 v50, v16, v52, v50
    v_dot2_f32_bf16 v51, v16, v16, v51
    v_dot2_f32_bf16 v50, v17, v52, v50
    v_dot2_f32_bf16 v51, v17, v17, v51
    v_dot2_f32_bf16 v50, v18, v52, v50
    v_dot2_f32_bf16 v51, v18, v18, v51
    v_dot2_f32_bf16 v50, v19, v52, v50
    v_dot2_f32_bf16 v51, v19, v19, v51
    v_dot2_f32_bf16 v50, v20, v52, v50
    v_dot2_f32_bf16 v51, v20, v20, v51
    v_dot2_f32_bf16 v50, v21, v52, v50
    v_dot2_f32_bf16 v51, v21, v21, v51
    v_dot2_f32_bf16 v50, v22, v52, v50
    v_dot2_f32_bf16 v51, v22, v22, v51
    v_dot2_f32_bf16 v50, v23, v52, v50
    v_dot2_f32_bf16 v51, v23, v23, v51
    v_dot2_f32_bf16 v50, v24, v52, v50
    v_dot2_f32_bf16 v51, v24, v24, v51
    v_dot2_f32_bf16 v50, v25, v52, v50
    v_dot2_f32_bf16 v51, v25, v25, v51
    v_dot2_f32_bf16 v50, v26, v52, v50
    v_dot2_f32_bf16 v51, v26, v26, v51
    v_dot2_f32_bf16 v50, v27, v52, v50
    v_dot2_f32_bf16 v51, v27, v27, v51
    v_dot2_f32_bf16 v50, v28, v52, v50
    v_dot2_f32_bf16 v51, v28, v28, v51
    v_dot2_f32_bf16 v50, v29, v52, v50
    v_dot2_f32_bf16 v51, v29, v29, v51
    v_dot2_f32_bf16 v50, v30, v52, v50
    v_dot2_f32_bf16 v51, v30, v30, v51
    v_dot2_f32_bf16 v50, v31, v52, v50
    v_dot2_f32_bf16 v51, v31, v31, v51
    v_dot2_f32_bf16 v50, v32, v52, v50
    v_dot2_f32_bf16 v51, v32, v32, v51
    v_dot2_f32_bf16 v50, v33, v52, v50
    v_dot2_f32_bf16 v51, v33, v33, v51
    v_dot2_f32_bf16 v50, v34, v52, v50
    v_dot2_f32_bf16 v51, v34, v34, v51
    v_dot2_f32_bf16 v50, v35, v52, v50
    v_dot2_f32_bf16 v51, v35, v35, v51
    v_dot2_f32_bf16 v50, v36, v52, v50
    v_dot2_f32_bf16 v51, v36, v36, v51
    v_dot2_f32_bf16 v50, v37, v52, v50
    v_dot2_f32_bf16 v51, v37, v37, v51
    v_dot2_f32_bf16 v50, v38, v52, v50
    v_dot2_f32_bf16 v51, v38, v38, v51
    v_dot2_f32_bf16 v50, v39, v52, v50
    v_dot2_f32_bf16 v51, v39, v39, v51
    s_nop 3
    v_add_f32_dpp v50, v50, v50 quad_perm:[1,0,3,2] row_mask:0xf bank_mask:0xf
    v_add_f32_dpp v51, v51, v51 quad_perm:[1,0,3,2] row_mask:0xf bank_mask:0xf
    s_nop 3
    v_add_f32_dpp v50, v50, v50 quad_perm:[2,3,0,1] row_mask:0xf bank_mask:0xf
    v_add_f32_dpp v51, v51, v51 quad_perm:[2,3,0,1] row_mask:0xf bank_mask:0xf
    s_nop 3
    v_add_f32_dpp v50, v50, v50 row_half_mirror row_mask:0xf bank_mask:0xf
    v_add_f32_dpp v51, v51, v51 row_half_mirror row_mask:0xf bank_mask:0xf
    s_nop 1
    v_mul_f32 v50, 0x3b000000, v50
    v_mul_f32 v51, 0x3b000000, v51
    v_fma_f32 v51, -v50, v50, v51
    v_max_f32 v51, 0, v51
    v_add_f32 v51, 0x3727c5ac, v51
    v_rsq_f32 v51, v51
    s_lshl_b32 s42, s40, 7
    s_add_u32 s42, s42, 4194304
    s_add_u32 s43, s42, 8192
    v_mul_f32 v50, v50, v51
    v_lshlrev_b32 v4, 2, v1
    v_cmp_eq_u32 vcc, 0, v2
    s_and_saveexec_b64 s[44:45], vcc
    buffer_store_dword v51, v4, s[20:23], s42 offen sc1
    buffer_store_dword v50, v4, s[20:23], s43 offen sc1
    s_waitcnt vmcnt(2)
    s_endpgm
K1_PACK:
    s_sub_u32 s40, s2, 320
    v_lshrrev_b32 v1, 6, v0
    v_and_b32 v2, 63, v0
    v_readfirstlane_b32 s41, v1
    v_and_b32 v3, 31, v2
    v_lshrrev_b32 v4, 5, v2
    v_and_b32 v5, 3, v3
    v_lshrrev_b32 v6, 3, v3
    v_lshl_add_u32 v7, v6, 2, v5
    v_bfe_u32 v8, v3, 2, 1
    v_and_b32 v9, 1, v6
    v_lshl_add_u32 v9, v9, 2, v5
    v_lshl_add_u32 v9, v8, 3, v9
    v_and_b32 v10, 16, v3
    v_add_u32 v9, v9, v10
    s_cmp_ge_u32 s40, 48
    s_cbranch_scc1 K1_PWO
    s_mul_i32 s42, s40, 43
    s_lshr_b32 s42, s42, 7
    s_mul_i32 s43, s42, 3
    s_sub_u32 s43, s40, s43
    s_mov_b32 s24, s12
    s_mov_b32 s25, s13
    s_mov_b32 s26, 1572864
    s_mov_b32 s44, 3072
    s_lshl_b32 s45, s43, 10
    s_lshl_b32 s46, s42, 6
    s_add_u32 s45, s45, s46
    s_mul_i32 s46, s42, 98304
    s_lshl_b32 s47, s43, 10
    s_add_u32 s46, s46, s47
    s_add_u32 s46, s46, 5242880
    s_mov_b32 s47, 3072
    s_branch K1_PGO
K1_PWO:
    s_sub_u32 s42, s40, 48
    s_mov_b32 s43, 2
    s_mov_b32 s24, s16
    s_mov_b32 s25, s17
    s_mov_b32 s26, 524288
    s_mov_b32 s44, 1024
    s_lshl_b32 s45, s42, 6
    s_lshl_b32 s46, s42, 15
    s_add_u32 s46, s46, 8388608
    s_mov_b32 s47, 1024
K1_PGO:
    s_mov_b32 s27, 0x20000
    s_lshl_b32 s48, s41, 7
    v_add_u32 v9, s48, v9
    v_mul_lo_u32 v9, v9, s44
    v_lshl_add_u32 v9, v4, 4, v9
    s_lshl_b32 s49, s44, 5
    buffer_load_dwordx4 v[16:19], v9, s[24:27], s45 offen
    buffer_load_dwordx4 v[20:23], v9, s[24:27], s45 offen offset:32
    s_add_u32 s45, s45, s49
    buffer_load_dwordx4 v[24:27], v9, s[24:27], s45 offen
    buffer_load_dwordx4 v[28:31], v9, s[24:27], s45 offen offset:32
    s_add_u32 s45, s45, s49
    buffer_load_dwordx4 v[32:35], v9, s[24:27], s45 offen
    buffer_load_dwordx4 v[36:39], v9, s[24:27], s45 offen offset:32
    s_add_u32 s45, s45, s49
    buffer_load_dwordx4 v[40:43], v9, s[24:27], s45 offen
    buffer_load_dwordx4 v[44:47], v9, s[24:27], s45 offen offset:32
    s_add_u32 s45, s45, s49
    s_cmp_eq_u32 s43, 2
    s_cbranch_scc1 K1_PID
    s_mov_b32 s28, s14
    s_mov_b32 s29, s15
    s_mov_b32 s30, 16384
    s_mov_b32 s31, 0x20000
    s_lshl_b32 s50, s42, 10
    v_lshlrev_b32 v10, 9, v8
    v_lshl_add_u32 v10, v4, 8, v10
    v_lshl_add_u32 v10, v7, 1, v10
    buffer_load_ushort v48, v10, s[28:31], s50 offen offset:0
    buffer_load_ushort v52, v10, s[28:31], s50 offen offset:32
    buffer_load_ushort v49, v10, s[28:31], s50 offen offset:64
    buffer_load_ushort v53, v10, s[28:31], s50 offen offset:96
    buffer_load_ushort v50, v10, s[28:31], s50 offen offset:128
    buffer_load_ushort v54, v10, s[28:31], s50 offen offset:160
    buffer_load_ushort v51, v10, s[28:31], s50 offen offset:192
    buffer_load_ushort v55, v10, s[28:31], s50 offen offset:224
    s_waitcnt vmcnt(0)
    v_lshl_or_b32 v48, v52, 16, v48
    v_lshl_or_b32 v49, v53, 16, v49
    v_lshl_or_b32 v50, v54, 16, v50
    v_lshl_or_b32 v51, v55, 16, v51
    s_branch K1_PB
K1_PID:
    v_lshlrev_b32 v10, 3, v4
    v_sub_u32 v10, v7, v10
    v_mov_b32 v11, 0x3f80
    v_mov_b32 v12, 0x3f800000
    v_cmp_eq_u32 vcc, 0, v10
    v_cmp_eq_u32 s[52:53], 1, v10
    s_nop 1
    v_cndmask_b32 v48, 0, v11, vcc
    v_cndmask_b32 v13, 0, v12, s[52:53]
    v_or_b32 v48, v48, v13
    v_cmp_eq_u32 vcc, 2, v10
    v_cmp_eq_u32 s[52:53], 3, v10
    s_nop 1
    v_cndmask_b32 v49, 0, v11, vcc
    v_cndmask_b32 v13, 0, v12, s[52:53]
    v_or_b32 v49, v49, v13
    v_cmp_eq_u32 vcc, 4, v10
    v_cmp_eq_u32 s[52:53], 5, v10
    s_nop 1
    v_cndmask_b32 v50, 0, v11, vcc
    v_cndmask_b32 v13, 0, v12, s[52:53]
    v_or_b32 v50, v50, v13
    v_cmp_eq_u32 vcc, 6, v10
    v_cmp_eq_u32 s[52:53], 7, v10
    s_nop 1
    v_cndmask_b32 v51, 0, v11, vcc
    v_cndmask_b32 v13, 0, v12, s[52:53]
    v_or_b32 v51, v51, v13
K1_PB:
    s_waitcnt vmcnt(0)
    v_cmp_eq_u32 vcc, 0, v8
    v_mov_b32 v60, 0
    v_mov_b32 v61, 0x3f803f80
    v_cndmask_b32 v52, 0, v48, vcc
    v_cndmask_b32 v56, v48, 0, vcc
    v_cndmask_b32 v53, 0, v49, vcc
    v_cndmask_b32 v57, v49, 0, vcc
    v_cndmask_b32 v54, 0, v50, vcc
    v_cndmask_b32 v58, v50, 0, vcc
    v_cndmask_b32 v55, 0, v51, vcc
    v_cndmask_b32 v59, v51, 0, vcc
    s_lshl_b32 s48, s41, 3
    s_mul_i32 s48, s48, s47
    s_add_u32 s46, s46, s48
    v_lshlrev_b32 v11, 4, v2
    v_mfma_f32_32x32x16_bf16 v[64:79], v[16:19], v[52:55], 0
    v_mfma_f32_32x32x16_bf16 v[64:79], v[20:23], v[56:59], v[64:79]
    v_mfma_f32_32x32x16_bf16 v[80:95], v[24:27], v[52:55], 0
    v_mfma_f32_32x32x16_bf16 v[80:95], v[28:31], v[56:59], v[80:95]
    v_mfma_f32_32x32x16_bf16 v[96:111], v[32:35], v[52:55], 0
    v_mfma_f32_32x32x16_bf16 v[96:111], v[36:39], v[56:59], v[96:111]
    v_mfma_f32_32x32x16_bf16 v[112:127], v[40:43], v[52:55], 0
    v_mfma_f32_32x32x16_bf16 v[112:127], v[44:47], v[56:59], v[112:127]
    s_nop 7
    s_nop 3
    v_cvt_pk_bf16_f32 v16, v64, v65
    v_cvt_pk_bf16_f32 v17, v66, v67
    v_cvt_pk_bf16_f32 v18, v68, v69
    v_cvt_pk_bf16_f32 v19, v70, v71
    v_cvt_pk_bf16_f32 v20, v72, v73
    v_cvt_pk_bf16_f32 v21, v74, v75
    v_cvt_pk_bf16_f32 v22, v76, v77
    v_cvt_pk_bf16_f32 v23, v78, v79
    v_dot2_f32_bf16 v60, v16, v61, v60
    v_dot2_f32_bf16 v60, v17, v61, v60
    v_dot2_f32_bf16 v60, v18, v61, v60
    v_dot2_f32_bf16 v60, v19, v61, v60
    v_dot2_f32_bf16 v60, v20, v61, v60
    v_dot2_f32_bf16 v60, v21, v61, v60
    v_dot2_f32_bf16 v60, v22, v61, v60
    v_dot2_f32_bf16 v60, v23, v61, v60
    buffer_store_dwordx4 v[16:19], v11, s[20:23], s46 offen sc1
    s_add_u32 s46, s46, s47
    buffer_store_dwordx4 v[20:23], v11, s[20:23], s46 offen sc1
    s_add_u32 s46, s46, s47
    v_cvt_pk_bf16_f32 v24, v80, v81
    v_cvt_pk_bf16_f32 v25, v82, v83
    v_cvt_pk_bf16_f32 v26, v84, v85
    v_cvt_pk_bf16_f32 v27, v86, v87
    v_cvt_pk_bf16_f32 v28, v88, v89
    v_cvt_pk_bf16_f32 v29, v90, v91
    v_cvt_pk_bf16_f32 v30, v92, v93
    v_cvt_pk_bf16_f32 v31, v94, v95
    v_dot2_f32_bf16 v60, v24, v61, v60
    v_dot2_f32_bf16 v60, v25, v61, v60
    v_dot2_f32_bf16 v60, v26, v61, v60
    v_dot2_f32_bf16 v60, v27, v61, v60
    v_dot2_f32_bf16 v60, v28, v61, v60
    v_dot2_f32_bf16 v60, v29, v61, v60
    v_dot2_f32_bf16 v60, v30, v61, v60
    v_dot2_f32_bf16 v60, v31, v61, v60
    buffer_store_dwordx4 v[24:27], v11, s[20:23], s46 offen sc1
    s_add_u32 s46, s46, s47
    buffer_store_dwordx4 v[28:31], v11, s[20:23], s46 offen sc1
    s_add_u32 s46, s46, s47
    v_cvt_pk_bf16_f32 v32, v96, v97
    v_cvt_pk_bf16_f32 v33, v98, v99
    v_cvt_pk_bf16_f32 v34, v100, v101
    v_cvt_pk_bf16_f32 v35, v102, v103
    v_cvt_pk_bf16_f32 v36, v104, v105
    v_cvt_pk_bf16_f32 v37, v106, v107
    v_cvt_pk_bf16_f32 v38, v108, v109
    v_cvt_pk_bf16_f32 v39, v110, v111
    v_dot2_f32_bf16 v60, v32, v61, v60
    v_dot2_f32_bf16 v60, v33, v61, v60
    v_dot2_f32_bf16 v60, v34, v61, v60
    v_dot2_f32_bf16 v60, v35, v61, v60
    v_dot2_f32_bf16 v60, v36, v61, v60
    v_dot2_f32_bf16 v60, v37, v61, v60
    v_dot2_f32_bf16 v60, v38, v61, v60
    v_dot2_f32_bf16 v60, v39, v61, v60
    buffer_store_dwordx4 v[32:35], v11, s[20:23], s46 offen sc1
    s_add_u32 s46, s46, s47
    buffer_store_dwordx4 v[36:39], v11, s[20:23], s46 offen sc1
    s_add_u32 s46, s46, s47
    v_cvt_pk_bf16_f32 v40, v112, v113
    v_cvt_pk_bf16_f32 v41, v114, v115
    v_cvt_pk_bf16_f32 v42, v116, v117
    v_cvt_pk_bf16_f32 v43, v118, v119
    v_cvt_pk_bf16_f32 v44, v120, v121
    v_cvt_pk_bf16_f32 v45, v122, v123
    v_cvt_pk_bf16_f32 v46, v124, v125
    v_cvt_pk_bf16_f32 v47, v126, v127
    v_dot2_f32_bf16 v60, v40, v61, v60
    v_dot2_f32_bf16 v60, v41, v61, v60
    v_dot2_f32_bf16 v60, v42, v61, v60
    v_dot2_f32_bf16 v60, v43, v61, v60
    v_dot2_f32_bf16 v60, v44, v61, v60
    v_dot2_f32_bf16 v60, v45, v61, v60
    v_dot2_f32_bf16 v60, v46, v61, v60
    v_dot2_f32_bf16 v60, v47, v61, v60
    buffer_store_dwordx4 v[40:43], v11, s[20:23], s46 offen sc1
    s_add_u32 s46, s46, s47
    buffer_store_dwordx4 v[44:47], v11, s[20:23], s46 offen sc1
    s_add_u32 s46, s46, s47
    v_lshlrev_b32 v12, 2, v0
    s_nop 2
    ds_write_b32 v12, v60
    v_lshlrev_b32 v13, 2, v3
    s_waitcnt lgkmcnt(0)
    s_barrier
    ds_read_b32 v20, v13 offset:0
    ds_read_b32 v21, v13 offset:128
    ds_read_b32 v22, v13 offset:256
    ds_read_b32 v23, v13 offset:384
    ds_read_b32 v24, v13 offset:512
    ds_read_b32 v25, v13 offset:640
    ds_read_b32 v26, v13 offset:768
    ds_read_b32 v27, v13 offset:896
    s_waitcnt lgkmcnt(0)
    v_add_f32 v20, v20, v21
    v_add_f32 v20, v20, v22
    v_add_f32 v20, v20, v23
    v_add_f32 v20, v20, v24
    v_add_f32 v20, v20, v25
    v_add_f32 v20, v20, v26
    v_add_f32 v20, v20, v27
    s_lshl_b32 s48, s40, 7
    s_add_u32 s48, s48, 7340032
    v_lshl_add_u32 v13, v8, 4, v7
    v_lshlrev_b32 v13, 2, v13
    v_cmp_gt_u32 vcc, 32, v0
    s_and_saveexec_b64 s[44:45], vcc
    s_cbranch_execz K1_DONE
    buffer_store_dword v20, v13, s[20:23], s48 offen sc1
K1_DONE:
    s_endpgm
.globl conv_kernel
.p2align 8
.type conv_kernel,@function
conv_kernel:
    s_cmp_ge_u32 s2, 256
    s_cbranch_scc1 K2_DONE
    s_load_dwordx4 s[4:7], s[0:1], 32
    s_load_dwordx2 s[18:19], s[0:1], 96
    v_lshrrev_b32 v1, 6, v0
    v_and_b32 v2, 63, v0
    v_readfirstlane_b32 s41, v1
    s_and_b32 s40, s2, 7
    s_lshl_b32 s40, s40, 6
    s_lshr_b32 s42, s2, 3
    s_lshl_b32 s42, s42, 1
    s_add_u32 s40, s40, s42
    s_lshr_b32 s42, s41, 1
    s_and_b32 s43, s41, 1
    s_add_u32 s44, s40, s42
    s_lshl_b32 s45, s44, 12
    s_lshl_b32 s46, s40, 1
    s_waitcnt lgkmcnt(0)
    s_add_u32 s6, s6, s46
    s_addc_u32 s7, s7, 0
    s_load_dword s47, s[6:7], 0
    s_mov_b32 s20, s18
    s_mov_b32 s21, s19
    s_mov_b32 s22, 33554432
    s_mov_b32 s23, 0x20000
    s_mov_b32 s24, s4
    s_mov_b32 s25, s5
    s_mov_b32 s26, 2097152
    s_mov_b32 s27, 0x20000
    s_mul_i32 s48, s42, 21248
    v_lshlrev_b32 v3, 4, v2
    s_mul_i32 s53, s43, 8320
    s_add_u32 s53, s53, s48
    s_lshl_b32 s54, s43, 2
    s_add_u32 s54, s54, s45
    s_add_u32 m0, s53, 32
    s_add_u32 s55, s54, 2
    buffer_load_dwordx4 v3, s[24:27], s54 offen offset:0 lds
    buffer_load_dwordx4 v3, s[24:27], s54 offen offset:1024 lds
    buffer_load_dwordx4 v3, s[24:27], s54 offen offset:2048 lds
    buffer_load_dwordx4 v3, s[24:27], s54 offen offset:3072 lds
    s_add_u32 m0, s53, 4192
    s_lshl_b32 s54, s43, 11
    buffer_load_dwordx4 v3, s[24:27], s55 offen offset:0 lds
    buffer_load_dwordx4 v3, s[24:27], s55 offen offset:1024 lds
    buffer_load_dwordx4 v3, s[24:27], s55 offen offset:2048 lds
    buffer_load_dwordx4 v3, s[24:27], s55 offen offset:3072 lds
    s_add_u32 s55, s54, s48
    s_add_u32 m0, s55, 16640
    s_add_u32 s54, s54, s45
    buffer_load_dwordx4 v3, s[20:23], s54 offen offset:0 lds
    buffer_load_dwordx4 v3, s[20:23], s54 offen offset:1024 lds
    v_and_b32 v4, 15, v2
    v_lshrrev_b32 v5, 4, v2
    v_add_u32 v8, v4, v5
    v_subrev_u32 v8, 16, v8
    v_lshlrev_b32 v9, 1, v8
    v_cmp_gt_i32 vcc, 0, v8
    v_add_u32 v9, s45, v9
    v_bfrev_b32 v10, 1
    v_cndmask_b32 v9, v9, v10, vcc
    buffer_load_ushort v17, v9, s[24:27], 0 offen
    v_lshlrev_b32 v6, 5, v4
    v_lshl_add_u32 v6, v5, 3, v6
    s_lshl_b32 s49, s43, 11
    v_add_u32 v6, s49, v6
    v_lshlrev_b32 v7, 1, v6
    s_add_u32 s50, s45, 2097152
    s_mov_b32 s51, 4194304
    s_mov_b32 s52, 4202496
    buffer_load_dwordx2 v[168:169], v6, s[20:23], s50 offen offset:0
    buffer_load_dwordx2 v[170:171], v6, s[20:23], s50 offen offset:512
    buffer_load_dwordx2 v[172:173], v6, s[20:23], s50 offen offset:1024
    buffer_load_dwordx2 v[174:175], v6, s[20:23], s50 offen offset:1536
    buffer_load_dwordx4 v[176:179], v7, s[20:23], s51 offen offset:0
    buffer_load_dwordx4 v[180:183], v7, s[20:23], s51 offen offset:1024
    buffer_load_dwordx4 v[184:187], v7, s[20:23], s51 offen offset:2048
    buffer_load_dwordx4 v[188:191], v7, s[20:23], s51 offen offset:3072
    buffer_load_dwordx4 v[192:195], v7, s[20:23], s52 offen offset:0
    buffer_load_dwordx4 v[196:199], v7, s[20:23], s52 offen offset:1024
    buffer_load_dwordx4 v[200:203], v7, s[20:23], s52 offen offset:2048
    buffer_load_dwordx4 v[204:207], v7, s[20:23], s52 offen offset:3072
    v_mov_b32 v8, 0
    v_mov_b32 v9, 0
    v_lshlrev_b32 v10, 3, v2
    s_add_u32 s53, s48, 20736
    v_add_u32 v10, s53, v10
    ds_write_b64 v10, v[8:9]
    v_mul_u32_u24 v11, 4160, v5
    v_lshl_add_u32 v11, v4, 1, v11
    v_add_u32 v11, s48, v11
    v_add_u32 v8, 1, v4
    v_and_b32 v9, 3, v8
    v_sub_u32 v8, v8, v9
    v_mul_u32_u24 v9, 4160, v9
    v_lshl_add_u32 v12, v8, 1, v9
    v_lshl_add_u32 v12, v5, 4, v12
    s_lshl_b32 s53, s43, 8
    s_add_u32 s53, s53, s48
    v_add_u32 v12, s53, v12
    v_lshlrev_b32 v13, 4, v5
    v_lshlrev_b32 v14, 5, v4
    v_sub_u32 v13, v13, v14
    s_add_u32 s54, s53, 17120
    v_add_u32 v13, s54, v13
    v_lshrrev_b32 v18, 3, v4
    v_lshlrev_b32 v18, 17, v18
    v_and_b32 v19, 7, v4
    v_lshl_add_u32 v18, v19, 5, v18
    v_lshl_add_u32 v18, v5, 3, v18
    s_lshl_b32 s58, s43, 20
    s_lshl_b32 s59, s44, 8
    s_add_u32 s58, s58, s59
    s_waitcnt vmcnt(12)
    ds_write_b16 v11, v17
    s_waitcnt lgkmcnt(0)
    s_barrier
    s_lshl_b32 s60, s2, 13
    s_add_u32 s60, s60, 5242880
    v_lshlrev_b32 v244, 4, v0
    buffer_load_dwordx4 v[240:243], v244, s[20:23], s60 offen
    s_add_u32 s60, s60, 4096
    buffer_load_dwordx4 v[240:243], v244, s[20:23], s60 offen
    ds_read_b64 v[40:41], v12 offset:0
    ds_read_b64 v[42:43], v12 offset:8
    ds_read_b128 v[72:75], v13 offset:3584
    ds_read_b128 v[76:79], v13 offset:3072
    ds_read_b128 v[80:83], v13 offset:2560
    ds_read_b128 v[84:87], v13 offset:2048
    ds_read_b128 v[88:91], v13 offset:1536
    ds_read_b128 v[92:95], v13 offset:1024
    ds_read_b128 v[96:99], v13 offset:512
    ds_read_b128 v[100:103], v13 offset:0
    ds_read_b64 v[44:45], v12 offset:512
    ds_read_b64 v[46:47], v12 offset:520
    ds_read_b64 v[48:49], v12 offset:1024
    ds_read_b64 v[50:51], v12 offset:1032
    ds_read_b64 v[52:53], v12 offset:1536
    ds_read_b64 v[54:55], v12 offset:1544
    ds_read_b64 v[56:57], v12 offset:2048
    ds_read_b64 v[58:59], v12 offset:2056
    ds_read_b64 v[60:61], v12 offset:2560
    ds_read_b64 v[62:63], v12 offset:2568
    ds_read_b64 v[64:65], v12 offset:3072
    ds_read_b64 v[66:67], v12 offset:3080
    ds_read_b64 v[68:69], v12 offset:3584
    ds_read_b64 v[70:71], v12 offset:3592
    s_waitcnt lgkmcnt(15)
    v_mfma_f32_16x16x32_bf16 v[208:211], v[40:43], v[72:75], 0
    s_waitcnt lgkmcnt(15)
    v_mfma_f32_16x16x32_bf16 v[212:215], v[40:43], v[76:79], 0
    s_waitcnt lgkmcnt(15)
    v_mfma_f32_16x16x32_bf16 v[216:219], v[40:43], v[80:83], 0
    s_waitcnt lgkmcnt(15)
    v_mfma_f32_16x16x32_bf16 v[220:223], v[40:43], v[84:87], 0
    s_waitcnt lgkmcnt(15)
    v_mfma_f32_16x16x32_bf16 v[224:227], v[40:43], v[88:91], 0
    s_waitcnt lgkmcnt(15)
    v_mfma_f32_16x16x32_bf16 v[228:231], v[40:43], v[92:95], 0
    s_waitcnt lgkmcnt(15)
    v_mfma_f32_16x16x32_bf16 v[232:235], v[40:43], v[96:99], 0
    s_waitcnt lgkmcnt(14)
    v_mfma_f32_16x16x32_bf16 v[236:239], v[40:43], v[100:103], 0
    s_waitcnt lgkmcnt(0)
    v_mfma_f32_16x16x32_bf16 v[212:215], v[44:47], v[72:75], v[212:215]
    ds_read_b64 v[104:105], v12 offset:64
    ds_read_b64 v[106:107], v12 offset:72
    v_mfma_f32_16x16x32_bf16 v[216:219], v[44:47], v[76:79], v[216:219]
    ds_read_b128 v[136:139], v13 offset:3648
    v_mfma_f32_16x16x32_bf16 v[220:223], v[44:47], v[80:83], v[220:223]
    ds_read_b128 v[140:143], v13 offset:3136
    v_mfma_f32_16x16x32_bf16 v[224:227], v[44:47], v[84:87], v[224:227]
    ds_read_b128 v[144:147], v13 offset:2624
    v_mfma_f32_16x16x32_bf16 v[228:231], v[44:47], v[88:91], v[228:231]
    ds_read_b128 v[148:151], v13 offset:2112
    v_mfma_f32_16x16x32_bf16 v[232:235], v[44:47], v[92:95], v[232:235]
    ds_read_b128 v[152:155], v13 offset:1600
    v_mfma_f32_16x16x32_bf16 v[236:239], v[44:47], v[96:99], v[236:239]
    ds_read_b128 v[156:159], v13 offset:1088
    v_mfma_f32_16x16x32_bf16 v[216:219], v[48:51], v[72:75], v[216:219]
    ds_read_b128 v[160:163], v13 offset:576
    v_mfma_f32_16x16x32_bf16 v[220:223], v[48:51], v[76:79], v[220:223]
    ds_read_b128 v[164:167], v13 offset:64
    v_mfma_f32_16x16x32_bf16 v[224:227], v[48:51], v[80:83], v[224:227]
    ds_read_b64 v[108:109], v12 offset:576
    ds_read_b64 v[110:111], v12 offset:584
    v_mfma_f32_16x16x32_bf16 v[228:231], v[48:51], v[84:87], v[228:231]
    ds_read_b64 v[112:113], v12 offset:1088
    ds_read_b64 v[114:115], v12 offset:1096
    v_mfma_f32_16x16x32_bf16 v[232:235], v[48:51], v[88:91], v[232:235]
    ds_read_b64 v[116:117], v12 offset:1600
    ds_read_b64 v[118:119], v12 offset:1608
    v_mfma_f32_16x16x32_bf16 v[236:239], v[48:51], v[92:95], v[236:239]
    ds_read_b64 v[120:121], v12 offset:2112
    ds_read_b64 v[122:123], v12 offset:2120
    v_mfma_f32_16x16x32_bf16 v[220:223], v[52:55], v[72:75], v[220:223]
    ds_read_b64 v[124:125], v12 offset:2624
    ds_read_b64 v[126:127], v12 offset:2632
    v_mfma_f32_16x16x32_bf16 v[224:227], v[52:55], v[76:79], v[224:227]
    ds_read_b64 v[128:129], v12 offset:3136
    ds_read_b64 v[130:131], v12 offset:3144
    v_mfma_f32_16x16x32_bf16 v[228:231], v[52:55], v[80:83], v[228:231]
    ds_read_b64 v[132:133], v12 offset:3648
    ds_read_b64 v[134:135], v12 offset:3656
    v_mfma_f32_16x16x32_bf16 v[232:235], v[52:55], v[84:87], v[232:235]
    v_mfma_f32_16x16x32_bf16 v[236:239], v[52:55], v[88:91], v[236:239]
    v_mfma_f32_16x16x32_bf16 v[224:227], v[56:59], v[72:75], v[224:227]
    v_mfma_f32_16x16x32_bf16 v[228:231], v[56:59], v[76:79], v[228:231]
    v_mfma_f32_16x16x32_bf16 v[232:235], v[56:59], v[80:83], v[232:235]
    v_mfma_f32_16x16x32_bf16 v[236:239], v[56:59], v[84:87], v[236:239]
    v_mfma_f32_16x16x32_bf16 v[228:231], v[60:63], v[72:75], v[228:231]
    v_mfma_f32_16x16x32_bf16 v[232:235], v[60:63], v[76:79], v[232:235]
    v_mfma_f32_16x16x32_bf16 v[236:239], v[60:63], v[80:83], v[236:239]
    v_mfma_f32_16x16x32_bf16 v[232:235], v[64:67], v[72:75], v[232:235]
    v_mfma_f32_16x16x32_bf16 v[236:239], v[64:67], v[76:79], v[236:239]
    v_mfma_f32_16x16x32_bf16 v[236:239], v[68:71], v[72:75], v[236:239]
    s_waitcnt lgkmcnt(0)
    v_mfma_f32_16x16x32_bf16 v[208:211], v[104:107], v[136:139], v[208:211]
    v_mfma_f32_16x16x32_bf16 v[212:215], v[104:107], v[140:143], v[212:215]
    v_mfma_f32_16x16x32_bf16 v[216:219], v[104:107], v[144:147], v[216:219]
    v_mfma_f32_16x16x32_bf16 v[220:223], v[104:107], v[148:151], v[220:223]
    v_mfma_f32_16x16x32_bf16 v[224:227], v[104:107], v[152:155], v[224:227]
    v_mfma_f32_16x16x32_bf16 v[228:231], v[104:107], v[156:159], v[228:231]
    v_mfma_f32_16x16x32_bf16 v[232:235], v[104:107], v[160:163], v[232:235]
    v_mfma_f32_16x16x32_bf16 v[236:239], v[104:107], v[164:167], v[236:239]
    v_mfma_f32_16x16x32_bf16 v[212:215], v[108:111], v[136:139], v[212:215]
    ds_read_b64 v[40:41], v12 offset:128
    ds_read_b64 v[42:43], v12 offset:136
    v_mfma_f32_16x16x32_bf16 v[216:219], v[108:111], v[140:143], v[216:219]
    ds_read_b128 v[72:75], v13 offset:3712
    v_mfma_f32_16x16x32_bf16 v[220:223], v[108:111], v[144:147], v[220:223]
    ds_read_b128 v[76:79], v13 offset:3200
    v_mfma_f32_16x16x32_bf16 v[224:227], v[108:111], v[148:151], v[224:227]
    ds_read_b128 v[80:83], v13 offset:2688
    v_mfma_f32_16x16x32_bf16 v[228:231], v[108:111], v[152:155], v[228:231]
    ds_read_b128 v[84:87], v13 offset:2176
    v_mfma_f32_16x16x32_bf16 v[232:235], v[108:111], v[156:159], v[232:235]
    ds_read_b128 v[88:91], v13 offset:1664
    v_mfma_f32_16x16x32_bf16 v[236:239], v[108:111], v[160:163], v[236:239]
    ds_read_b128 v[92:95], v13 offset:1152
    v_mfma_f32_16x16x32_bf16 v[216:219], v[112:115], v[136:139], v[216:219]
    ds_read_b128 v[96:99], v13 offset:640
    v_mfma_f32_16x16x32_bf16 v[220:223], v[112:115], v[140:143], v[220:223]
    ds_read_b128 v[100:103], v13 offset:128
    v_mfma_f32_16x16x32_bf16 v[224:227], v[112:115], v[144:147], v[224:227]
    ds_read_b64 v[44:45], v12 offset:640
    ds_read_b64 v[46:47], v12 offset:648
    v_mfma_f32_16x16x32_bf16 v[228:231], v[112:115], v[148:151], v[228:231]
    ds_read_b64 v[48:49], v12 offset:1152
    ds_read_b64 v[50:51], v12 offset:1160
    v_mfma_f32_16x16x32_bf16 v[232:235], v[112:115], v[152:155], v[232:235]
    ds_read_b64 v[52:53], v12 offset:1664
    ds_read_b64 v[54:55], v12 offset:1672
    v_mfma_f32_16x16x32_bf16 v[236:239], v[112:115], v[156:159], v[236:239]
    ds_read_b64 v[56:57], v12 offset:2176
    ds_read_b64 v[58:59], v12 offset:2184
    v_mfma_f32_16x16x32_bf16 v[220:223], v[116:119], v[136:139], v[220:223]
    ds_read_b64 v[60:61], v12 offset:2688
    ds_read_b64 v[62:63], v12 offset:2696
    v_mfma_f32_16x16x32_bf16 v[224:227], v[116:119], v[140:143], v[224:227]
    ds_read_b64 v[64:65], v12 offset:3200
    ds_read_b64 v[66:67], v12 offset:3208
    v_mfma_f32_16x16x32_bf16 v[228:231], v[116:119], v[144:147], v[228:231]
    ds_read_b64 v[68:69], v12 offset:3712
    ds_read_b64 v[70:71], v12 offset:3720
    v_mfma_f32_16x16x32_bf16 v[232:235], v[116:119], v[148:151], v[232:235]
    v_mfma_f32_16x16x32_bf16 v[236:239], v[116:119], v[152:155], v[236:239]
    v_mfma_f32_16x16x32_bf16 v[224:227], v[120:123], v[136:139], v[224:227]
    v_mfma_f32_16x16x32_bf16 v[228:231], v[120:123], v[140:143], v[228:231]
    v_mfma_f32_16x16x32_bf16 v[232:235], v[120:123], v[144:147], v[232:235]
    v_mfma_f32_16x16x32_bf16 v[236:239], v[120:123], v[148:151], v[236:239]
    v_mfma_f32_16x16x32_bf16 v[228:231], v[124:127], v[136:139], v[228:231]
    v_mfma_f32_16x16x32_bf16 v[232:235], v[124:127], v[140:143], v[232:235]
    v_mfma_f32_16x16x32_bf16 v[236:239], v[124:127], v[144:147], v[236:239]
    v_mfma_f32_16x16x32_bf16 v[232:235], v[128:131], v[136:139], v[232:235]
    v_mfma_f32_16x16x32_bf16 v[236:239], v[128:131], v[140:143], v[236:239]
    v_mfma_f32_16x16x32_bf16 v[236:239], v[132:135], v[136:139], v[236:239]
    s_waitcnt lgkmcnt(0)
    v_mfma_f32_16x16x32_bf16 v[208:211], v[40:43], v[72:75], v[208:211]
    v_mfma_f32_16x16x32_bf16 v[212:215], v[40:43], v[76:79], v[212:215]
    v_mfma_f32_16x16x32_bf16 v[216:219], v[40:43], v[80:83], v[216:219]
    v_mfma_f32_16x16x32_bf16 v[220:223], v[40:43], v[84:87], v[220:223]
    v_mfma_f32_16x16x32_bf16 v[224:227], v[40:43], v[88:91], v[224:227]
    v_mfma_f32_16x16x32_bf16 v[228:231], v[40:43], v[92:95], v[228:231]
    v_mfma_f32_16x16x32_bf16 v[232:235], v[40:43], v[96:99], v[232:235]
    v_mfma_f32_16x16x32_bf16 v[236:239], v[40:43], v[100:103], v[236:239]
    v_mfma_f32_16x16x32_bf16 v[212:215], v[44:47], v[72:75], v[212:215]
    ds_read_b64 v[104:105], v12 offset:192
    ds_read_b64 v[106:107], v12 offset:200
    v_mfma_f32_16x16x32_bf16 v[216:219], v[44:47], v[76:79], v[216:219]
    ds_read_b128 v[136:139], v13 offset:3776
    v_mfma_f32_16x16x32_bf16 v[220:223], v[44:47], v[80:83], v[220:223]
    ds_read_b128 v[140:143], v13 offset:3264
    v_mfma_f32_16x16x32_bf16 v[224:227], v[44:47], v[84:87], v[224:227]
    ds_read_b128 v[144:147], v13 offset:2752
    v_mfma_f32_16x16x32_bf16 v[228:231], v[44:47], v[88:91], v[228:231]
    ds_read_b128 v[148:151], v13 offset:2240
    v_mfma_f32_16x16x32_bf16 v[232:235], v[44:47], v[92:95], v[232:235]
    ds_read_b128 v[152:155], v13 offset:1728
    v_mfma_f32_16x16x32_bf16 v[236:239], v[44:47], v[96:99], v[236:239]
    ds_read_b128 v[156:159], v13 offset:1216
    v_mfma_f32_16x16x32_bf16 v[216:219], v[48:51], v[72:75], v[216:219]
    ds_read_b128 v[160:163], v13 offset:704
    v_mfma_f32_16x16x32_bf16 v[220:223], v[48:51], v[76:79], v[220:223]
    ds_read_b128 v[164:167], v13 offset:192
    v_mfma_f32_16x16x32_bf16 v[224:227], v[48:51], v[80:83], v[224:227]
    ds_read_b64 v[108:109], v12 offset:704
    ds_read_b64 v[110:111], v12 offset:712
    v_mfma_f32_16x16x32_bf16 v[228:231], v[48:51], v[84:87], v[228:231]
    ds_read_b64 v[112:113], v12 offset:1216
    ds_read_b64 v[114:115], v12 offset:1224
    v_mfma_f32_16x16x32_bf16 v[232:235], v[48:51], v[88:91], v[232:235]
    ds_read_b64 v[116:117], v12 offset:1728
    ds_read_b64 v[118:119], v12 offset:1736
    v_mfma_f32_16x16x32_bf16 v[236:239], v[48:51], v[92:95], v[236:239]
    ds_read_b64 v[120:121], v12 offset:2240
    ds_read_b64 v[122:123], v12 offset:2248
    v_mfma_f32_16x16x32_bf16 v[220:223], v[52:55], v[72:75], v[220:223]
    ds_read_b64 v[124:125], v12 offset:2752
    ds_read_b64 v[126:127], v12 offset:2760
    v_mfma_f32_16x16x32_bf16 v[224:227], v[52:55], v[76:79], v[224:227]
    ds_read_b64 v[128:129], v12 offset:3264
    ds_read_b64 v[130:131], v12 offset:3272
    v_mfma_f32_16x16x32_bf16 v[228:231], v[52:55], v[80:83], v[228:231]
    ds_read_b64 v[132:133], v12 offset:3776
    ds_read_b64 v[134:135], v12 offset:3784
    v_mfma_f32_16x16x32_bf16 v[232:235], v[52:55], v[84:87], v[232:235]
    v_mfma_f32_16x16x32_bf16 v[236:239], v[52:55], v[88:91], v[236:239]
    v_mfma_f32_16x16x32_bf16 v[224:227], v[56:59], v[72:75], v[224:227]
    v_mfma_f32_16x16x32_bf16 v[228:231], v[56:59], v[76:79], v[228:231]
    v_mfma_f32_16x16x32_bf16 v[232:235], v[56:59], v[80:83], v[232:235]
    v_mfma_f32_16x16x32_bf16 v[236:239], v[56:59], v[84:87], v[236:239]
    v_mfma_f32_16x16x32_bf16 v[228:231], v[60:63], v[72:75], v[228:231]
    v_mfma_f32_16x16x32_bf16 v[232:235], v[60:63], v[76:79], v[232:235]
    v_mfma_f32_16x16x32_bf16 v[236:239], v[60:63], v[80:83], v[236:239]
    v_mfma_f32_16x16x32_bf16 v[232:235], v[64:67], v[72:75], v[232:235]
    v_mfma_f32_16x16x32_bf16 v[236:239], v[64:67], v[76:79], v[236:239]
    v_mfma_f32_16x16x32_bf16 v[236:239], v[68:71], v[72:75], v[236:239]
    s_waitcnt lgkmcnt(0)
    v_mfma_f32_16x16x32_bf16 v[208:211], v[104:107], v[136:139], v[208:211]
    v_mfma_f32_16x16x32_bf16 v[212:215], v[104:107], v[140:143], v[212:215]
    v_mfma_f32_16x16x32_bf16 v[216:219], v[104:107], v[144:147], v[216:219]
    v_mfma_f32_16x16x32_bf16 v[220:223], v[104:107], v[148:151], v[220:223]
    v_mfma_f32_16x16x32_bf16 v[224:227], v[104:107], v[152:155], v[224:227]
    v_mfma_f32_16x16x32_bf16 v[228:231], v[104:107], v[156:159], v[228:231]
    v_mfma_f32_16x16x32_bf16 v[232:235], v[104:107], v[160:163], v[232:235]
    v_mfma_f32_16x16x32_bf16 v[236:239], v[104:107], v[164:167], v[236:239]
    v_mfma_f32_16x16x32_bf16 v[212:215], v[108:111], v[136:139], v[212:215]
    v_mfma_f32_16x16x32_bf16 v[216:219], v[108:111], v[140:143], v[216:219]
    v_mfma_f32_16x16x32_bf16 v[220:223], v[108:111], v[144:147], v[220:223]
    v_mfma_f32_16x16x32_bf16 v[224:227], v[108:111], v[148:151], v[224:227]
    v_mfma_f32_16x16x32_bf16 v[228:231], v[108:111], v[152:155], v[228:231]
    v_mfma_f32_16x16x32_bf16 v[232:235], v[108:111], v[156:159], v[232:235]
    v_mfma_f32_16x16x32_bf16 v[236:239], v[108:111], v[160:163], v[236:239]
    v_mfma_f32_16x16x32_bf16 v[216:219], v[112:115], v[136:139], v[216:219]
    v_mfma_f32_16x16x32_bf16 v[220:223], v[112:115], v[140:143], v[220:223]
    v_mfma_f32_16x16x32_bf16 v[224:227], v[112:115], v[144:147], v[224:227]
    v_mfma_f32_16x16x32_bf16 v[228:231], v[112:115], v[148:151], v[228:231]
    v_mfma_f32_16x16x32_bf16 v[232:235], v[112:115], v[152:155], v[232:235]
    v_mfma_f32_16x16x32_bf16 v[236:239], v[112:115], v[156:159], v[236:239]
    v_mfma_f32_16x16x32_bf16 v[220:223], v[116:119], v[136:139], v[220:223]
    v_mfma_f32_16x16x32_bf16 v[224:227], v[116:119], v[140:143], v[224:227]
    v_mfma_f32_16x16x32_bf16 v[228:231], v[116:119], v[144:147], v[228:231]
    v_mfma_f32_16x16x32_bf16 v[232:235], v[116:119], v[148:151], v[232:235]
    v_mfma_f32_16x16x32_bf16 v[236:239], v[116:119], v[152:155], v[236:239]
    v_mfma_f32_16x16x32_bf16 v[224:227], v[120:123], v[136:139], v[224:227]
    v_mfma_f32_16x16x32_bf16 v[228:231], v[120:123], v[140:143], v[228:231]
    v_mfma_f32_16x16x32_bf16 v[232:235], v[120:123], v[144:147], v[232:235]
    v_mfma_f32_16x16x32_bf16 v[236:239], v[120:123], v[148:151], v[236:239]
    v_mfma_f32_16x16x32_bf16 v[228:231], v[124:127], v[136:139], v[228:231]
    v_mfma_f32_16x16x32_bf16 v[232:235], v[124:127], v[140:143], v[232:235]
    v_mfma_f32_16x16x32_bf16 v[236:239], v[124:127], v[144:147], v[236:239]
    v_mfma_f32_16x16x32_bf16 v[232:235], v[128:131], v[136:139], v[232:235]
    v_mfma_f32_16x16x32_bf16 v[236:239], v[128:131], v[140:143], v[236:239]
    v_mfma_f32_16x16x32_bf16 v[236:239], v[132:135], v[136:139], v[236:239]
    s_lshl_b32 s53, s41, 12
    s_add_u32 s53, s53, 42496
    s_xor_b32 s54, s41, 1
    s_lshl_b32 s54, s54, 12
    s_add_u32 s54, s54, 42496
    v_add_u32 v14, s53, v3
    v_add_u32 v15, s54, v3
    s_sub_u32 s55, 19192, s49
    s_add_u32 s55, s55, s48
    v_lshlrev_b32 v16, 5, v4
    v_lshl_add_u32 v16, v5, 3, v16
    v_sub_u32 v16, s55, v16
    s_lshl_b32 s56, s47, 16
    s_and_b32 s57, s47, 0xffff0000
    s_cmp_eq_u32 s42, 0
    s_cselect_b32 s56, s56, s57
    s_mov_b32 s44, 0xffff0000
    s_cmp_eq_u32 s43, 1
    s_cbranch_scc1 K2_X1
    ds_write_b128 v14, v[224:227] offset:0
    ds_write_b128 v14, v[228:231] offset:1024
    ds_write_b128 v14, v[232:235] offset:2048
    ds_write_b128 v14, v[236:239] offset:3072
    s_branch K2_X2
K2_X1:
    ds_write_b128 v14, v[208:211] offset:0
    ds_write_b128 v14, v[212:215] offset:1024
    ds_write_b128 v14, v[216:219] offset:2048
    ds_write_b128 v14, v[220:223] offset:3072
    s_nop 1
    v_mov_b32 v208, v224
    v_mov_b32 v209, v225
    v_mov_b32 v210, v226
    v_mov_b32 v211, v227
    v_mov_b32 v212, v228
    v_mov_b32 v213, v229
    v_mov_b32 v214, v230
    v_mov_b32 v215, v231
    v_mov_b32 v216, v232
    v_mov_b32 v217, v233
    v_mov_b32 v218, v234
    v_mov_b32 v219, v235
    v_mov_b32 v220, v236
    v_mov_b32 v221, v237
    v_mov_b32 v222, v238
    v_mov_b32 v223, v239
K2_X2:
    ds_read_b64 v[40:41], v16 offset:1536
    ds_read_b64 v[42:43], v16 offset:1024
    ds_read_b64 v[44:45], v16 offset:512
    ds_read_b64 v[46:47], v16 offset:0
    s_waitcnt lgkmcnt(0)
    s_barrier
    ds_read_b128 v[48:51], v15 offset:0
    ds_read_b128 v[52:55], v15 offset:1024
    ds_read_b128 v[56:59], v15 offset:2048
    ds_read_b128 v[60:63], v15 offset:3072
    s_add_u32 s50, s58, 9437184
    s_add_u32 s51, s58, 11534336
    s_waitcnt vmcnt(0) lgkmcnt(0)
    v_and_b32 v100, s44, v41
    v_lshlrev_b32 v101, 16, v41
    v_and_b32 v102, s44, v40
    v_lshlrev_b32 v103, 16, v40
    v_add_f32 v208, v208, v48
    v_fmac_f32 v208, s56, v100
    v_add_f32 v209, v209, v49
    v_fmac_f32 v209, s56, v101
    v_add_f32 v210, v210, v50
    v_fmac_f32 v210, s56, v102
    v_add_f32 v211, v211, v51
    v_fmac_f32 v211, s56, v103
    v_cvt_pk_bf16_f32 v110, v208, v209
    v_cvt_pk_bf16_f32 v111, v210, v211
    v_lshlrev_b32 v100, 16, v168
    v_and_b32 v101, s44, v168
    v_lshlrev_b32 v102, 16, v169
    v_and_b32 v103, s44, v169
    v_lshlrev_b32 v104, 16, v110
    v_and_b32 v105, s44, v110
    v_lshlrev_b32 v106, 16, v111
    v_and_b32 v107, s44, v111
    buffer_store_dwordx2 v[110:111], v18, s[20:23], s50 offen sc1
    s_add_u32 s50, s50, 0x40000
    v_fma_f32 v176, v100, v176, -v192
    v_fmac_f32 v100, v176, v104
    v_fma_f32 v177, v101, v177, -v193
    v_fmac_f32 v101, v177, v105
    v_fma_f32 v178, v102, v178, -v194
    v_fmac_f32 v102, v178, v106
    v_fma_f32 v179, v103, v179, -v195
    v_fmac_f32 v103, v179, v107
    v_cvt_pk_bf16_f32 v120, v100, v101
    v_cvt_pk_bf16_f32 v121, v102, v103
    buffer_store_dwordx2 v[120:121], v18, s[20:23], s51 offen sc1
    s_add_u32 s51, s51, 0x40000
    v_and_b32 v100, s44, v43
    v_lshlrev_b32 v101, 16, v43
    v_and_b32 v102, s44, v42
    v_lshlrev_b32 v103, 16, v42
    v_add_f32 v212, v212, v52
    v_fmac_f32 v212, s56, v100
    v_add_f32 v213, v213, v53
    v_fmac_f32 v213, s56, v101
    v_add_f32 v214, v214, v54
    v_fmac_f32 v214, s56, v102
    v_add_f32 v215, v215, v55
    v_fmac_f32 v215, s56, v103
    v_cvt_pk_bf16_f32 v112, v212, v213
    v_cvt_pk_bf16_f32 v113, v214, v215
    v_lshlrev_b32 v100, 16, v170
    v_and_b32 v101, s44, v170
    v_lshlrev_b32 v102, 16, v171
    v_and_b32 v103, s44, v171
    v_lshlrev_b32 v104, 16, v112
    v_and_b32 v105, s44, v112
    v_lshlrev_b32 v106, 16, v113
    v_and_b32 v107, s44, v113
    buffer_store_dwordx2 v[112:113], v18, s[20:23], s50 offen sc1
    s_add_u32 s50, s50, 0x40000
    v_fma_f32 v180, v100, v180, -v196
    v_fmac_f32 v100, v180, v104
    v_fma_f32 v181, v101, v181, -v197
    v_fmac_f32 v101, v181, v105
    v_fma_f32 v182, v102, v182, -v198
    v_fmac_f32 v102, v182, v106
    v_fma_f32 v183, v103, v183, -v199
    v_fmac_f32 v103, v183, v107
    v_cvt_pk_bf16_f32 v122, v100, v101
    v_cvt_pk_bf16_f32 v123, v102, v103
    buffer_store_dwordx2 v[122:123], v18, s[20:23], s51 offen sc1
    s_add_u32 s51, s51, 0x40000
    v_and_b32 v100, s44, v45
    v_lshlrev_b32 v101, 16, v45
    v_and_b32 v102, s44, v44
    v_lshlrev_b32 v103, 16, v44
    v_add_f32 v216, v216, v56
    v_fmac_f32 v216, s56, v100
    v_add_f32 v217, v217, v57
    v_fmac_f32 v217, s56, v101
    v_add_f32 v218, v218, v58
    v_fmac_f32 v218, s56, v102
    v_add_f32 v219, v219, v59
    v_fmac_f32 v219, s56, v103
    v_cvt_pk_bf16_f32 v114, v216, v217
    v_cvt_pk_bf16_f32 v115, v218, v219
    v_lshlrev_b32 v100, 16, v172
    v_and_b32 v101, s44, v172
    v_lshlrev_b32 v102, 16, v173
    v_and_b32 v103, s44, v173
    v_lshlrev_b32 v104, 16, v114
    v_and_b32 v105, s44, v114
    v_lshlrev_b32 v106, 16, v115
    v_and_b32 v107, s44, v115
    buffer_store_dwordx2 v[114:115], v18, s[20:23], s50 offen sc1
    s_add_u32 s50, s50, 0x40000
    v_fma_f32 v184, v100, v184, -v200
    v_fmac_f32 v100, v184, v104
    v_fma_f32 v185, v101, v185, -v201
    v_fmac_f32 v101, v185, v105
    v_fma_f32 v186, v102, v186, -v202
    v_fmac_f32 v102, v186, v106
    v_fma_f32 v187, v103, v187, -v203
    v_fmac_f32 v103, v187, v107
    v_cvt_pk_bf16_f32 v124, v100, v101
    v_cvt_pk_bf16_f32 v125, v102, v103
    buffer_store_dwordx2 v[124:125], v18, s[20:23], s51 offen sc1
    s_add_u32 s51, s51, 0x40000
    v_and_b32 v100, s44, v47
    v_lshlrev_b32 v101, 16, v47
    v_and_b32 v102, s44, v46
    v_lshlrev_b32 v103, 16, v46
    v_add_f32 v220, v220, v60
    v_fmac_f32 v220, s56, v100
    v_add_f32 v221, v221, v61
    v_fmac_f32 v221, s56, v101
    v_add_f32 v222, v222, v62
    v_fmac_f32 v222, s56, v102
    v_add_f32 v223, v223, v63
    v_fmac_f32 v223, s56, v103
    v_cvt_pk_bf16_f32 v116, v220, v221
    v_cvt_pk_bf16_f32 v117, v222, v223
    v_lshlrev_b32 v100, 16, v174
    v_and_b32 v101, s44, v174
    v_lshlrev_b32 v102, 16, v175
    v_and_b32 v103, s44, v175
    v_lshlrev_b32 v104, 16, v116
    v_and_b32 v105, s44, v116
    v_lshlrev_b32 v106, 16, v117
    v_and_b32 v107, s44, v117
    buffer_store_dwordx2 v[116:117], v18, s[20:23], s50 offen sc1
    s_add_u32 s50, s50, 0x40000
    v_fma_f32 v188, v100, v188, -v204
    v_fmac_f32 v100, v188, v104
    v_fma_f32 v189, v101, v189, -v205
    v_fmac_f32 v101, v189, v105
    v_fma_f32 v190, v102, v190, -v206
    v_fmac_f32 v102, v190, v106
    v_fma_f32 v191, v103, v191, -v207
    v_fmac_f32 v103, v191, v107
    v_cvt_pk_bf16_f32 v126, v100, v101
    v_cvt_pk_bf16_f32 v127, v102, v103
    buffer_store_dwordx2 v[126:127], v18, s[20:23], s51 offen sc1
    s_add_u32 s51, s51, 0x40000
K2_DONE:
    s_endpgm
.globl qkv1_kernel
.p2align 8
.type qkv1_kernel,@function
qkv1_kernel:
    s_cmp_ge_u32 s2, 256
    s_cbranch_scc1 K3_DONE
    s_load_dwordx2 s[18:19], s[0:1], 96
    s_load_dwordx2 s[16:17], s[0:1], 80
    v_lshrrev_b32 v1, 6, v0
    v_and_b32 v2, 63, v0
    v_readfirstlane_b32 s41, v1
    s_and_b32 s42, s2, 7
    s_lshr_b32 s43, s2, 3
    s_lshr_b32 s44, s42, 1
    s_lshl_b32 s44, s44, 2
    s_and_b32 s45, s43, 3
    s_add_u32 s44, s44, s45
    s_and_b32 s45, s42, 1
    s_lshl_b32 s45, s45, 3
    s_lshr_b32 s46, s43, 2
    s_add_u32 s45, s45, s46
    v_lshrrev_b32 v3, 4, v2
    v_and_b32 v4, 15, v2
    v_lshlrev_b32 v5, 2, v3
    v_xor_b32 v5, v5, v4
    v_lshlrev_b32 v5, 4, v5
    v_lshl_add_u32 v5, v3, 8, v5
    v_lshlrev_b32 v6, 4, v2
    v_lshrrev_b32 v7, 5, v2
    v_and_b32 v8, 31, v2
    s_lshl_b32 s47, s45, 5
    s_lshl_b32 s48, s41, 4
    s_add_u32 s47, s47, s48
    s_lshl_b32 s48, s44, 17
    s_add_u32 s48, s48, 11534336
    s_lshl_b32 s49, s45, 1
    s_add_u32 s49, s49, s41
    s_mul_i32 s50, s45, 98304
    s_add_u32 s50, s50, 5242880
    s_lshl_b32 s51, s41, 12
    s_mul_i32 s52, s41, 3072
    s_add_u32 s52, s52, 16384
    s_mul_i32 s53, s45, 384
    s_add_u32 s53, s53, 7340032
    v_lshlrev_b32 v9, 6, v7
    s_waitcnt lgkmcnt(0)
    s_mov_b32 s20, s18
    s_mov_b32 s21, s19
    s_mov_b32 s22, 33554432
    s_mov_b32 s23, 0x20000
    s_cmp_lt_u32 s41, 4
    s_cbranch_scc1 K3_C
    s_sub_u32 s41, s41, 4
    s_lshl_b32 s41, s41, 1
    s_lshl_b32 s47, s45, 5
    s_lshl_b32 s51, s41, 4
    s_add_u32 s47, s47, s51
    s_lshl_b32 s49, s45, 1
    s_add_u32 s49, s49, s41
    s_lshl_b32 s51, s41, 12
    s_mul_i32 s52, s41, 3072
    s_add_u32 s52, s52, 16384
    s_add_u32 s54, s47, 0
    s_and_b32 s54, s54, 511
    s_lshl_b32 s54, s54, 8
    s_add_u32 m0, s51, 0
    s_add_u32 s54, s54, s48
    buffer_load_dwordx4 v5, s[20:23], s54 offen offset:0 lds
    buffer_load_dwordx4 v5, s[20:23], s54 offen offset:1024 lds
    buffer_load_dwordx4 v5, s[20:23], s54 offen offset:2048 lds
    buffer_load_dwordx4 v5, s[20:23], s54 offen offset:3072 lds
    s_add_u32 s54, s49, 0
    s_and_b32 s54, s54, 31
    s_mul_i32 s54, s54, 3072
    s_add_u32 m0, s52, 0
    s_add_u32 s54, s54, s50
    buffer_load_dwordx4 v6, s[20:23], s54 offen offset:0 lds
    buffer_load_dwordx4 v6, s[20:23], s54 offen offset:1024 lds
    buffer_load_dwordx4 v6, s[20:23], s54 offen offset:2048 lds
    s_add_u32 s54, s47, 16
    s_and_b32 s54, s54, 511
    s_lshl_b32 s54, s54, 8
    s_add_u32 m0, s51, 4096
    s_add_u32 s54, s54, s48
    buffer_load_dwordx4 v5, s[20:23], s54 offen offset:0 lds
    buffer_load_dwordx4 v5, s[20:23], s54 offen offset:1024 lds
    buffer_load_dwordx4 v5, s[20:23], s54 offen offset:2048 lds
    buffer_load_dwordx4 v5, s[20:23], s54 offen offset:3072 lds
    s_add_u32 s54, s49, 1
    s_and_b32 s54, s54, 31
    s_mul_i32 s54, s54, 3072
    s_add_u32 m0, s52, 3072
    s_add_u32 s54, s54, s50
    buffer_load_dwordx4 v6, s[20:23], s54 offen offset:0 lds
    buffer_load_dwordx4 v6, s[20:23], s54 offen offset:1024 lds
    buffer_load_dwordx4 v6, s[20:23], s54 offen offset:2048 lds
    s_add_u32 s54, s47, 64
    s_and_b32 s54, s54, 511
    s_lshl_b32 s54, s54, 8
    s_add_u32 m0, s51, 28672
    s_add_u32 s54, s54, s48
    buffer_load_dwordx4 v5, s[20:23], s54 offen offset:0 lds
    buffer_load_dwordx4 v5, s[20:23], s54 offen offset:1024 lds
    buffer_load_dwordx4 v5, s[20:23], s54 offen offset:2048 lds
    buffer_load_dwordx4 v5, s[20:23], s54 offen offset:3072 lds
    s_add_u32 s54, s49, 4
    s_and_b32 s54, s54, 31
    s_mul_i32 s54, s54, 3072
    s_add_u32 m0, s52, 28672
    s_add_u32 s54, s54, s50
    buffer_load_dwordx4 v6, s[20:23], s54 offen offset:0 lds
    buffer_load_dwordx4 v6, s[20:23], s54 offen offset:1024 lds
    buffer_load_dwordx4 v6, s[20:23], s54 offen offset:2048 lds
    s_add_u32 s54, s47, 80
    s_and_b32 s54, s54, 511
    s_lshl_b32 s54, s54, 8
    s_add_u32 m0, s51, 32768
    s_add_u32 s54, s54, s48
    buffer_load_dwordx4 v5, s[20:23], s54 offen offset:0 lds
    buffer_load_dwordx4 v5, s[20:23], s54 offen offset:1024 lds
    buffer_load_dwordx4 v5, s[20:23], s54 offen offset:2048 lds
    buffer_load_dwordx4 v5, s[20:23], s54 offen offset:3072 lds
    s_add_u32 s54, s49, 5
    s_and_b32 s54, s54, 31
    s_mul_i32 s54, s54, 3072
    s_add_u32 m0, s52, 31744
    s_add_u32 s54, s54, s50
    buffer_load_dwordx4 v6, s[20:23], s54 offen offset:0 lds
    buffer_load_dwordx4 v6, s[20:23], s54 offen offset:1024 lds
    buffer_load_dwordx4 v6, s[20:23], s54 offen offset:2048 lds
    s_add_u32 s54, s47, 128
    s_and_b32 s54, s54, 511
    s_lshl_b32 s54, s54, 8
    s_add_u32 m0, s51, 57344
    s_add_u32 s54, s54, s48
    buffer_load_dwordx4 v5, s[20:23], s54 offen offset:0 lds
    buffer_load_dwordx4 v5, s[20:23], s54 offen offset:1024 lds
    buffer_load_dwordx4 v5, s[20:23], s54 offen offset:2048 lds
    buffer_load_dwordx4 v5, s[20:23], s54 offen offset:3072 lds
    s_add_u32 s54, s49, 8
    s_and_b32 s54, s54, 31
    s_mul_i32 s54, s54, 3072
    s_add_u32 m0, s52, 57344
    s_add_u32 s54, s54, s50
    buffer_load_dwordx4 v6, s[20:23], s54 offen offset:0 lds
    buffer_load_dwordx4 v6, s[20:23], s54 offen offset:1024 lds
    buffer_load_dwordx4 v6, s[20:23], s54 offen offset:2048 lds
    s_add_u32 s54, s47, 144
    s_and_b32 s54, s54, 511
    s_lshl_b32 s54, s54, 8
    s_add_u32 m0, s51, 61440
    s_add_u32 s54, s54, s48
    buffer_load_dwordx4 v5, s[20:23], s54 offen offset:0 lds
    buffer_load_dwordx4 v5, s[20:23], s54 offen offset:1024 lds
    buffer_load_dwordx4 v5, s[20:23], s54 offen offset:2048 lds
    buffer_load_dwordx4 v5, s[20:23], s54 offen offset:3072 lds
    s_add_u32 s54, s49, 9
    s_and_b32 s54, s54, 31
    s_mul_i32 s54, s54, 3072
    s_add_u32 m0, s52, 60416
    s_add_u32 s54, s54, s50
    buffer_load_dwordx4 v6, s[20:23], s54 offen offset:0 lds
    buffer_load_dwordx4 v6, s[20:23], s54 offen offset:1024 lds
    buffer_load_dwordx4 v6, s[20:23], s54 offen offset:2048 lds
    s_add_u32 s54, s47, 192
    s_and_b32 s54, s54, 511
    s_lshl_b32 s54, s54, 8
    s_add_u32 m0, s51, 86016
    s_add_u32 s54, s54, s48
    buffer_load_dwordx4 v5, s[20:23], s54 offen offset:0 lds
    buffer_load_dwordx4 v5, s[20:23], s54 offen offset:1024 lds
    buffer_load_dwordx4 v5, s[20:23], s54 offen offset:2048 lds
    buffer_load_dwordx4 v5, s[20:23], s54 offen offset:3072 lds
    s_add_u32 s54, s49, 12
    s_and_b32 s54, s54, 31
    s_mul_i32 s54, s54, 3072
    s_add_u32 m0, s52, 86016
    s_add_u32 s54, s54, s50
    buffer_load_dwordx4 v6, s[20:23], s54 offen offset:0 lds
    buffer_load_dwordx4 v6, s[20:23], s54 offen offset:1024 lds
    buffer_load_dwordx4 v6, s[20:23], s54 offen offset:2048 lds
    s_add_u32 s54, s47, 208
    s_and_b32 s54, s54, 511
    s_lshl_b32 s54, s54, 8
    s_add_u32 m0, s51, 90112
    s_add_u32 s54, s54, s48
    buffer_load_dwordx4 v5, s[20:23], s54 offen offset:0 lds
    buffer_load_dwordx4 v5, s[20:23], s54 offen offset:1024 lds
    buffer_load_dwordx4 v5, s[20:23], s54 offen offset:2048 lds
    buffer_load_dwordx4 v5, s[20:23], s54 offen offset:3072 lds
    s_add_u32 s54, s49, 13
    s_and_b32 s54, s54, 31
    s_mul_i32 s54, s54, 3072
    s_add_u32 m0, s52, 89088
    s_add_u32 s54, s54, s50
    buffer_load_dwordx4 v6, s[20:23], s54 offen offset:0 lds
    buffer_load_dwordx4 v6, s[20:23], s54 offen offset:1024 lds
    buffer_load_dwordx4 v6, s[20:23], s54 offen offset:2048 lds
    s_mov_b32 s24, s16
    s_mov_b32 s25, s17
    s_mov_b32 s26, 2097152
    s_mov_b32 s27, 0x20000
    v_lshlrev_b32 v204, 7, v2
    s_lshl_b32 s56, s42, 18
    s_lshl_b32 s57, s43, 13
    s_add_u32 s56, s56, s57
    s_waitcnt vmcnt(42)
    s_barrier
    s_add_u32 s54, s47, 256
    s_and_b32 s54, s54, 511
    s_lshl_b32 s54, s54, 8
    s_add_u32 m0, s51, 114688
    s_add_u32 s54, s54, s48
    buffer_load_dwordx4 v5, s[20:23], s54 offen offset:0 lds
    buffer_load_dwordx4 v5, s[20:23], s54 offen offset:1024 lds
    buffer_load_dwordx4 v5, s[20:23], s54 offen offset:2048 lds
    buffer_load_dwordx4 v5, s[20:23], s54 offen offset:3072 lds
    s_add_u32 s54, s49, 16
    s_and_b32 s54, s54, 31
    s_mul_i32 s54, s54, 3072
    s_add_u32 m0, s52, 114688
    s_add_u32 s54, s54, s50
    buffer_load_dwordx4 v6, s[20:23], s54 offen offset:0 lds
    buffer_load_dwordx4 v6, s[20:23], s54 offen offset:1024 lds
    buffer_load_dwordx4 v6, s[20:23], s54 offen offset:2048 lds
    s_add_u32 s54, s47, 272
    s_and_b32 s54, s54, 511
    s_lshl_b32 s54, s54, 8
    s_add_u32 m0, s51, 118784
    s_add_u32 s54, s54, s48
    buffer_load_dwordx4 v5, s[20:23], s54 offen offset:0 lds
    buffer_load_dwordx4 v5, s[20:23], s54 offen offset:1024 lds
    buffer_load_dwordx4 v5, s[20:23], s54 offen offset:2048 lds
    buffer_load_dwordx4 v5, s[20:23], s54 offen offset:3072 lds
    s_add_u32 s54, s49, 17
    s_and_b32 s54, s54, 31
    s_mul_i32 s54, s54, 3072
    s_add_u32 m0, s52, 117760
    s_add_u32 s54, s54, s50
    buffer_load_dwordx4 v6, s[20:23], s54 offen offset:0 lds
    buffer_load_dwordx4 v6, s[20:23], s54 offen offset:1024 lds
    buffer_load_dwordx4 v6, s[20:23], s54 offen offset:2048 lds
    s_waitcnt vmcnt(42)
    s_barrier
    s_add_u32 s54, s47, 320
    s_and_b32 s54, s54, 511
    s_lshl_b32 s54, s54, 8
    s_add_u32 m0, s51, 0
    s_add_u32 s54, s54, s48
    buffer_load_dwordx4 v5, s[20:23], s54 offen offset:0 lds
    buffer_load_dwordx4 v5, s[20:23], s54 offen offset:1024 lds
    buffer_load_dwordx4 v5, s[20:23], s54 offen offset:2048 lds
    buffer_load_dwordx4 v5, s[20:23], s54 offen offset:3072 lds
    s_add_u32 s54, s49, 20
    s_and_b32 s54, s54, 31
    s_mul_i32 s54, s54, 3072
    s_add_u32 m0, s52, 0
    s_add_u32 s54, s54, s50
    buffer_load_dwordx4 v6, s[20:23], s54 offen offset:0 lds
    buffer_load_dwordx4 v6, s[20:23], s54 offen offset:1024 lds
    buffer_load_dwordx4 v6, s[20:23], s54 offen offset:2048 lds
    s_add_u32 s54, s47, 336
    s_and_b32 s54, s54, 511
    s_lshl_b32 s54, s54, 8
    s_add_u32 m0, s51, 4096
    s_add_u32 s54, s54, s48
    buffer_load_dwordx4 v5, s[20:23], s54 offen offset:0 lds
    buffer_load_dwordx4 v5, s[20:23], s54 offen offset:1024 lds
    buffer_load_dwordx4 v5, s[20:23], s54 offen offset:2048 lds
    buffer_load_dwordx4 v5, s[20:23], s54 offen offset:3072 lds
    s_add_u32 s54, s49, 21
    s_and_b32 s54, s54, 31
    s_mul_i32 s54, s54, 3072
    s_add_u32 m0, s52, 3072
    s_add_u32 s54, s54, s50
    buffer_load_dwordx4 v6, s[20:23], s54 offen offset:0 lds
    buffer_load_dwordx4 v6, s[20:23], s54 offen offset:1024 lds
    buffer_load_dwordx4 v6, s[20:23], s54 offen offset:2048 lds
    s_waitcnt vmcnt(42)
    s_barrier
    s_add_u32 s54, s47, 384
    s_and_b32 s54, s54, 511
    s_lshl_b32 s54, s54, 8
    s_add_u32 m0, s51, 28672
    s_add_u32 s54, s54, s48
    buffer_load_dwordx4 v5, s[20:23], s54 offen offset:0 lds
    buffer_load_dwordx4 v5, s[20:23], s54 offen offset:1024 lds
    buffer_load_dwordx4 v5, s[20:23], s54 offen offset:2048 lds
    buffer_load_dwordx4 v5, s[20:23], s54 offen offset:3072 lds
    s_add_u32 s54, s49, 24
    s_and_b32 s54, s54, 31
    s_mul_i32 s54, s54, 3072
    s_add_u32 m0, s52, 28672
    s_add_u32 s54, s54, s50
    buffer_load_dwordx4 v6, s[20:23], s54 offen offset:0 lds
    buffer_load_dwordx4 v6, s[20:23], s54 offen offset:1024 lds
    buffer_load_dwordx4 v6, s[20:23], s54 offen offset:2048 lds
    s_add_u32 s54, s47, 400
    s_and_b32 s54, s54, 511
    s_lshl_b32 s54, s54, 8
    s_add_u32 m0, s51, 32768
    s_add_u32 s54, s54, s48
    buffer_load_dwordx4 v5, s[20:23], s54 offen offset:0 lds
    buffer_load_dwordx4 v5, s[20:23], s54 offen offset:1024 lds
    buffer_load_dwordx4 v5, s[20:23], s54 offen offset:2048 lds
    buffer_load_dwordx4 v5, s[20:23], s54 offen offset:3072 lds
    s_add_u32 s54, s49, 25
    s_and_b32 s54, s54, 31
    s_mul_i32 s54, s54, 3072
    s_add_u32 m0, s52, 31744
    s_add_u32 s54, s54, s50
    buffer_load_dwordx4 v6, s[20:23], s54 offen offset:0 lds
    buffer_load_dwordx4 v6, s[20:23], s54 offen offset:1024 lds
    buffer_load_dwordx4 v6, s[20:23], s54 offen offset:2048 lds
    s_waitcnt vmcnt(42)
    s_barrier
    s_add_u32 s54, s47, 448
    s_and_b32 s54, s54, 511
    s_lshl_b32 s54, s54, 8
    s_add_u32 m0, s51, 57344
    s_add_u32 s54, s54, s48
    buffer_load_dwordx4 v5, s[20:23], s54 offen offset:0 lds
    buffer_load_dwordx4 v5, s[20:23], s54 offen offset:1024 lds
    buffer_load_dwordx4 v5, s[20:23], s54 offen offset:2048 lds
    buffer_load_dwordx4 v5, s[20:23], s54 offen offset:3072 lds
    s_add_u32 s54, s49, 28
    s_and_b32 s54, s54, 31
    s_mul_i32 s54, s54, 3072
    s_add_u32 m0, s52, 57344
    s_add_u32 s54, s54, s50
    buffer_load_dwordx4 v6, s[20:23], s54 offen offset:0 lds
    buffer_load_dwordx4 v6, s[20:23], s54 offen offset:1024 lds
    buffer_load_dwordx4 v6, s[20:23], s54 offen offset:2048 lds
    s_add_u32 s54, s47, 464
    s_and_b32 s54, s54, 511
    s_lshl_b32 s54, s54, 8
    s_add_u32 m0, s51, 61440
    s_add_u32 s54, s54, s48
    buffer_load_dwordx4 v5, s[20:23], s54 offen offset:0 lds
    buffer_load_dwordx4 v5, s[20:23], s54 offen offset:1024 lds
    buffer_load_dwordx4 v5, s[20:23], s54 offen offset:2048 lds
    buffer_load_dwordx4 v5, s[20:23], s54 offen offset:3072 lds
    s_add_u32 s54, s49, 29
    s_and_b32 s54, s54, 31
    s_mul_i32 s54, s54, 3072
    s_add_u32 m0, s52, 60416
    s_add_u32 s54, s54, s50
    buffer_load_dwordx4 v6, s[20:23], s54 offen offset:0 lds
    buffer_load_dwordx4 v6, s[20:23], s54 offen offset:1024 lds
    buffer_load_dwordx4 v6, s[20:23], s54 offen offset:2048 lds
    s_mov_b32 m0, 143360
    s_nop 0
    buffer_load_dwordx4 v6, s[20:23], s53 offen lds
    s_lshl_b32 s54, s2, 11
    s_lshl_b32 s55, s41, 9
    s_add_u32 s54, s54, s55
    s_add_u32 s54, s54, 8388608
    buffer_load_dwordx4 v[200:203], v6, s[20:23], s54 offen
    buffer_load_dword v205, v204, s[24:27], s56 offen
    s_waitcnt vmcnt(45)
    s_barrier
    s_waitcnt vmcnt(31)
    s_barrier
    s_waitcnt vmcnt(17)
    s_barrier
    s_waitcnt vmcnt(2)
    s_barrier
    s_lshr_b32 s41, s41, 1
    v_and_b32 v5, 15, v2
    v_lshrrev_b32 v6, 2, v5
    v_lshl_add_u32 v6, v7, 3, v6
    v_mul_u32_u24 v6, 336, v6
    v_bfe_u32 v9, v2, 4, 1
    v_lshl_add_u32 v6, v9, 5, v6
    v_and_b32 v5, 3, v5
    v_lshl_add_u32 v6, v5, 3, v6
    s_lshl_b32 s55, s41, 6
    v_add_u32 v6, s55, v6
    s_barrier
    ds_read_b64_tr_b16 v[128:129], v6 offset:128
    ds_read_b64_tr_b16 v[132:133], v6 offset:0
    ds_read_b64_tr_b16 v[130:131], v6 offset:1472
    ds_read_b64_tr_b16 v[134:135], v6 offset:1344
    ds_read_b64_tr_b16 v[136:137], v6 offset:5504
    ds_read_b64_tr_b16 v[140:141], v6 offset:5376
    ds_read_b64_tr_b16 v[138:139], v6 offset:6848
    ds_read_b64_tr_b16 v[142:143], v6 offset:6720
    ds_read_b64_tr_b16 v[144:145], v6 offset:10880
    ds_read_b64_tr_b16 v[148:149], v6 offset:10752
    ds_read_b64_tr_b16 v[146:147], v6 offset:12224
    ds_read_b64_tr_b16 v[150:151], v6 offset:12096
    s_waitcnt lgkmcnt(8)
    v_mfma_f32_32x32x16_bf16 v[36:51], v[128:131], v[132:135], 0
    ds_read_b64_tr_b16 v[152:153], v6 offset:16256
    ds_read_b64_tr_b16 v[156:157], v6 offset:16128
    ds_read_b64_tr_b16 v[154:155], v6 offset:17600
    ds_read_b64_tr_b16 v[158:159], v6 offset:17472
    s_waitcnt lgkmcnt(8)
    v_mfma_f32_32x32x16_bf16 v[36:51], v[136:139], v[140:143], v[36:51]
    ds_read_b64_tr_b16 v[160:161], v6 offset:21632
    ds_read_b64_tr_b16 v[164:165], v6 offset:21504
    ds_read_b64_tr_b16 v[162:163], v6 offset:22976
    ds_read_b64_tr_b16 v[166:167], v6 offset:22848
    s_waitcnt lgkmcnt(8)
    v_mfma_f32_32x32x16_bf16 v[36:51], v[144:147], v[148:151], v[36:51]
    ds_read_b64_tr_b16 v[168:169], v6 offset:27008
    ds_read_b64_tr_b16 v[172:173], v6 offset:26880
    ds_read_b64_tr_b16 v[170:171], v6 offset:28352
    ds_read_b64_tr_b16 v[174:175], v6 offset:28224
    s_waitcnt lgkmcnt(8)
    v_mfma_f32_32x32x16_bf16 v[36:51], v[152:155], v[156:159], v[36:51]
    ds_read_b64_tr_b16 v[176:177], v6 offset:32384
    ds_read_b64_tr_b16 v[180:181], v6 offset:32256
    ds_read_b64_tr_b16 v[178:179], v6 offset:33728
    ds_read_b64_tr_b16 v[182:183], v6 offset:33600
    s_waitcnt lgkmcnt(8)
    v_mfma_f32_32x32x16_bf16 v[36:51], v[160:163], v[164:167], v[36:51]
    ds_read_b64_tr_b16 v[184:185], v6 offset:37760
    ds_read_b64_tr_b16 v[188:189], v6 offset:37632
    ds_read_b64_tr_b16 v[186:187], v6 offset:39104
    ds_read_b64_tr_b16 v[190:191], v6 offset:38976
    s_waitcnt lgkmcnt(8)
    v_mfma_f32_32x32x16_bf16 v[36:51], v[168:171], v[172:175], v[36:51]
    s_waitcnt lgkmcnt(4)
    v_mfma_f32_32x32x16_bf16 v[36:51], v[176:179], v[180:183], v[36:51]
    s_waitcnt lgkmcnt(0)
    v_mfma_f32_32x32x16_bf16 v[36:51], v[184:187], v[188:191], v[36:51]
    v_lshlrev_b32 v5, 2, v8
    v_lshl_add_u32 v5, v7, 9, v5
    s_lshl_b32 s55, s45, 1
    s_add_u32 s55, s55, s41
    s_mul_i32 s55, s55, 2176
    s_add_u32 s55, s55, 25165824
    s_nop 7
    buffer_atomic_add_f32 v36, v5, s[20:23], s55 offen offset:0
    buffer_atomic_add_f32 v37, v5, s[20:23], s55 offen offset:128
    buffer_atomic_add_f32 v38, v5, s[20:23], s55 offen offset:256
    buffer_atomic_add_f32 v39, v5, s[20:23], s55 offen offset:384
    buffer_atomic_add_f32 v40, v5, s[20:23], s55 offen offset:1024
    buffer_atomic_add_f32 v41, v5, s[20:23], s55 offen offset:1152
    buffer_atomic_add_f32 v42, v5, s[20:23], s55 offen offset:1280
    buffer_atomic_add_f32 v43, v5, s[20:23], s55 offen offset:1408
    s_mov_b32 exec_hi, 0
    buffer_atomic_add_f32 v44, v5, s[20:23], s55 offen offset:2048
    s_endpgm
K3_C:
    v_lshrrev_b32 v16, 2, v4
    v_lshl_add_u32 v17, v7, 3, v16
    v_lshlrev_b32 v17, 8, v17
    v_xor_b32 v16, s41, v16
    v_lshl_add_u32 v17, v16, 6, v17
    v_and_b32 v16, 1, v3
    v_lshl_add_u32 v17, v16, 5, v17
    v_and_b32 v16, 3, v4
    v_lshl_add_u32 v10, v16, 3, v17
    v_add_u32 v11, 57344, v10
    v_add_u32 v12, 114688, v10
    v_add_u32 v13, 16384, v6
    v_add_u32 v14, 73728, v6
    v_add_u32 v15, 131072, v6
    v_lshrrev_b32 v16, 2, v4
    v_lshl_add_u32 v17, v3, 3, v16
    v_lshlrev_b32 v17, 8, v17
    v_xor_b32 v16, s41, v16
    v_lshl_add_u32 v17, v16, 6, v17
    v_and_b32 v16, 3, v4
    v_lshl_add_u32 v16, v16, 3, v17
    v_add_u32 v17, 57344, v16
    v_add_u32 v19, 114688, v16
    v_add_u32 v9, 143360, v9
    v_mov_b32 v252, 0x3f803f80
    v_mov_b32 v253, 0x3f803f80
    v_mov_b32 v254, 0x3f803f80
    v_mov_b32 v255, 0x3f803f80
    v_lshlrev_b32 v3, 5, v8
    v_lshl_add_u32 v3, v7, 4, v3
    s_lshl_b32 s54, s44, 17
    s_lshl_b32 s55, s41, 15
    s_add_u32 s54, s54, s55
    s_lshl_b32 s55, s45, 11
    s_add_u32 s54, s54, s55
    s_add_u32 s54, s54, 15728640
    s_waitcnt lgkmcnt(0)
    s_barrier
    ds_read_b64_tr_b16 v[68:69], v10 offset:0
    ds_read_b64_tr_b16 v[70:71], v10 offset:1024
    ds_read_b128 v[72:75], v13 offset:0
    ds_read_b64_tr_b16 v[196:197], v16 offset:0
    ds_read_b64_tr_b16 v[198:199], v16 offset:1024
    ds_read_b128 v[76:79], v13 offset:1024
    ds_read_b128 v[80:83], v13 offset:2048
    ds_read_b64_tr_b16 v[84:85], v10 offset:4096
    ds_read_b64_tr_b16 v[86:87], v10 offset:5120
    ds_read_b128 v[88:91], v13 offset:3072
    ds_read_b64_tr_b16 v[200:201], v16 offset:32
    ds_read_b64_tr_b16 v[202:203], v16 offset:1056
    ds_read_b128 v[92:95], v13 offset:4096
    ds_read_b128 v[96:99], v13 offset:5120
    ds_read_b64_tr_b16 v[100:101], v10 offset:8192
    ds_read_b64_tr_b16 v[102:103], v10 offset:9216
    ds_read_b128 v[104:107], v13 offset:6144
    ds_read_b64_tr_b16 v[204:205], v16 offset:8192
    ds_read_b64_tr_b16 v[206:207], v16 offset:9216
    ds_read_b128 v[108:111], v13 offset:7168
    ds_read_b128 v[112:115], v13 offset:8192
    ds_read_b64_tr_b16 v[116:117], v10 offset:12288
    ds_read_b64_tr_b16 v[118:119], v10 offset:13312
    ds_read_b128 v[120:123], v13 offset:9216
    ds_read_b64_tr_b16 v[208:209], v16 offset:8224
    ds_read_b64_tr_b16 v[210:211], v16 offset:9248
    ds_read_b128 v[124:127], v13 offset:10240
    ds_read_b128 v[128:131], v13 offset:11264
    s_waitcnt lgkmcnt(0)
    s_barrier
    v_mfma_f32_32x32x16_bf16 v[36:51], v[76:79], v[68:71], 0
    ds_read_b64_tr_b16 v[132:133], v10 offset:28672
    ds_read_b64_tr_b16 v[134:135], v10 offset:29696
    ds_read_b128 v[136:139], v13 offset:28672
    v_mfma_f32_32x32x16_bf16 v[52:67], v[80:83], v[68:71], 0
    ds_read_b64_tr_b16 v[212:213], v16 offset:28672
    ds_read_b64_tr_b16 v[214:215], v16 offset:29696
    ds_read_b128 v[140:143], v13 offset:29696
    v_mfma_f32_16x16x32_bf16 v[228:231], v[196:199], v[196:199], 0
    v_mfma_f32_32x32x16_bf16 v[20:35], v[72:75], v[68:71], 0
    ds_read_b128 v[144:147], v13 offset:30720
    v_mfma_f32_16x16x32_bf16 v[236:239], v[252:255], v[196:199], 0
    v_mov_b32 v244, v68
    v_mov_b32 v245, v69
    v_mov_b32 v246, v70
    v_mov_b32 v247, v71
    v_mfma_f32_32x32x16_bf16 v[36:51], v[92:95], v[84:87], v[36:51]
    ds_read_b64_tr_b16 v[148:149], v10 offset:32768
    ds_read_b64_tr_b16 v[150:151], v10 offset:33792
    ds_read_b128 v[152:155], v13 offset:31744
    v_mfma_f32_32x32x16_bf16 v[52:67], v[96:99], v[84:87], v[52:67]
    ds_read_b64_tr_b16 v[216:217], v16 offset:28704
    ds_read_b64_tr_b16 v[218:219], v16 offset:29728
    ds_read_b128 v[156:159], v13 offset:32768
    v_mfma_f32_16x16x32_bf16 v[232:235], v[200:203], v[200:203], 0
    v_mfma_f32_32x32x16_bf16 v[20:35], v[88:91], v[84:87], v[20:35]
    ds_read_b128 v[160:163], v13 offset:33792
    v_mfma_f32_16x16x32_bf16 v[240:243], v[252:255], v[200:203], 0
    v_mov_b32 v248, v84
    v_mov_b32 v249, v85
    v_mov_b32 v250, v86
    v_mov_b32 v251, v87
    v_mfma_f32_32x32x16_bf16 v[36:51], v[108:111], v[100:103], v[36:51]
    ds_read_b64_tr_b16 v[164:165], v10 offset:36864
    ds_read_b64_tr_b16 v[166:167], v10 offset:37888
    ds_read_b128 v[168:171], v13 offset:34816
    v_mfma_f32_32x32x16_bf16 v[52:67], v[112:115], v[100:103], v[52:67]
    ds_read_b64_tr_b16 v[220:221], v16 offset:36864
    ds_read_b64_tr_b16 v[222:223], v16 offset:37888
    ds_read_b128 v[172:175], v13 offset:35840
    v_mfma_f32_16x16x32_bf16 v[228:231], v[204:207], v[204:207], v[228:231]
    v_mfma_f32_32x32x16_bf16 v[20:35], v[104:107], v[100:103], v[20:35]
    ds_read_b128 v[176:179], v13 offset:36864
    v_mfma_f32_16x16x32_bf16 v[236:239], v[252:255], v[204:207], v[236:239]
    v_mfma_f32_32x32x16_bf16 v[36:51], v[124:127], v[116:119], v[36:51]
    ds_read_b64_tr_b16 v[180:181], v10 offset:40960
    ds_read_b64_tr_b16 v[182:183], v10 offset:41984
    ds_read_b128 v[184:187], v13 offset:37888
    v_mfma_f32_32x32x16_bf16 v[52:67], v[128:131], v[116:119], v[52:67]
    ds_read_b64_tr_b16 v[224:225], v16 offset:36896
    ds_read_b64_tr_b16 v[226:227], v16 offset:37920
    ds_read_b128 v[188:191], v13 offset:38912
    v_mfma_f32_16x16x32_bf16 v[232:235], v[208:211], v[208:211], v[232:235]
    v_mfma_f32_32x32x16_bf16 v[20:35], v[120:123], v[116:119], v[20:35]
    ds_read_b128 v[192:195], v13 offset:39936
    v_mfma_f32_16x16x32_bf16 v[240:243], v[252:255], v[208:211], v[240:243]
    s_waitcnt lgkmcnt(0)
    s_barrier
    v_mfma_f32_32x32x16_bf16 v[36:51], v[140:143], v[132:135], v[36:51]
    ds_read_b64_tr_b16 v[68:69], v11 offset:0
    ds_read_b64_tr_b16 v[70:71], v11 offset:1024
    ds_read_b128 v[72:75], v14 offset:0
    v_mfma_f32_32x32x16_bf16 v[52:67], v[144:147], v[132:135], v[52:67]
    ds_read_b64_tr_b16 v[196:197], v17 offset:0
    ds_read_b64_tr_b16 v[198:199], v17 offset:1024
    ds_read_b128 v[76:79], v14 offset:1024
    v_mfma_f32_16x16x32_bf16 v[228:231], v[212:215], v[212:215], v[228:231]
    v_mfma_f32_32x32x16_bf16 v[20:35], v[136:139], v[132:135], v[20:35]
    ds_read_b128 v[80:83], v14 offset:2048
    v_mfma_f32_16x16x32_bf16 v[236:239], v[252:255], v[212:215], v[236:239]
    v_mfma_f32_32x32x16_bf16 v[36:51], v[156:159], v[148:151], v[36:51]
    ds_read_b64_tr_b16 v[84:85], v11 offset:4096
    ds_read_b64_tr_b16 v[86:87], v11 offset:5120
    ds_read_b128 v[88:91], v14 offset:3072
    v_mfma_f32_32x32x16_bf16 v[52:67], v[160:163], v[148:151], v[52:67]
    ds_read_b64_tr_b16 v[200:201], v17 offset:32
    ds_read_b64_tr_b16 v[202:203], v17 offset:1056
    ds_read_b128 v[92:95], v14 offset:4096
    v_mfma_f32_16x16x32_bf16 v[232:235], v[216:219], v[216:219], v[232:235]
    v_mfma_f32_32x32x16_bf16 v[20:35], v[152:155], v[148:151], v[20:35]
    ds_read_b128 v[96:99], v14 offset:5120
    v_mfma_f32_16x16x32_bf16 v[240:243], v[252:255], v[216:219], v[240:243]
    v_mfma_f32_32x32x16_bf16 v[36:51], v[172:175], v[164:167], v[36:51]
    ds_read_b64_tr_b16 v[100:101], v11 offset:8192
    ds_read_b64_tr_b16 v[102:103], v11 offset:9216
    ds_read_b128 v[104:107], v14 offset:6144
    v_mfma_f32_32x32x16_bf16 v[52:67], v[176:179], v[164:167], v[52:67]
    ds_read_b64_tr_b16 v[204:205], v17 offset:8192
    ds_read_b64_tr_b16 v[206:207], v17 offset:9216
    ds_read_b128 v[108:111], v14 offset:7168
    v_mfma_f32_16x16x32_bf16 v[228:231], v[220:223], v[220:223], v[228:231]
    v_mfma_f32_32x32x16_bf16 v[20:35], v[168:171], v[164:167], v[20:35]
    ds_read_b128 v[112:115], v14 offset:8192
    v_mfma_f32_16x16x32_bf16 v[236:239], v[252:255], v[220:223], v[236:239]
    v_mfma_f32_32x32x16_bf16 v[36:51], v[188:191], v[180:183], v[36:51]
    ds_read_b64_tr_b16 v[116:117], v11 offset:12288
    ds_read_b64_tr_b16 v[118:119], v11 offset:13312
    ds_read_b128 v[120:123], v14 offset:9216
    v_mfma_f32_32x32x16_bf16 v[52:67], v[192:195], v[180:183], v[52:67]
    ds_read_b64_tr_b16 v[208:209], v17 offset:8224
    ds_read_b64_tr_b16 v[210:211], v17 offset:9248
    ds_read_b128 v[124:127], v14 offset:10240
    v_mfma_f32_16x16x32_bf16 v[232:235], v[224:227], v[224:227], v[232:235]
    v_mfma_f32_32x32x16_bf16 v[20:35], v[184:187], v[180:183], v[20:35]
    ds_read_b128 v[128:131], v14 offset:11264
    v_mfma_f32_16x16x32_bf16 v[240:243], v[252:255], v[224:227], v[240:243]
    s_waitcnt lgkmcnt(0)
    s_barrier
    v_mfma_f32_32x32x16_bf16 v[36:51], v[76:79], v[68:71], v[36:51]
    ds_read_b64_tr_b16 v[132:133], v11 offset:28672
    ds_read_b64_tr_b16 v[134:135], v11 offset:29696
    ds_read_b128 v[136:139], v14 offset:28672
    v_mfma_f32_32x32x16_bf16 v[52:67], v[80:83], v[68:71], v[52:67]
    ds_read_b64_tr_b16 v[212:213], v17 offset:28672
    ds_read_b64_tr_b16 v[214:215], v17 offset:29696
    ds_read_b128 v[140:143], v14 offset:29696
    v_mfma_f32_16x16x32_bf16 v[228:231], v[196:199], v[196:199], v[228:231]
    v_mfma_f32_32x32x16_bf16 v[20:35], v[72:75], v[68:71], v[20:35]
    ds_read_b128 v[144:147], v14 offset:30720
    v_mfma_f32_16x16x32_bf16 v[236:239], v[252:255], v[196:199], v[236:239]
    v_mfma_f32_32x32x16_bf16 v[36:51], v[92:95], v[84:87], v[36:51]
    ds_read_b64_tr_b16 v[148:149], v11 offset:32768
    ds_read_b64_tr_b16 v[150:151], v11 offset:33792
    ds_read_b128 v[152:155], v14 offset:31744
    v_mfma_f32_32x32x16_bf16 v[52:67], v[96:99], v[84:87], v[52:67]
    ds_read_b64_tr_b16 v[216:217], v17 offset:28704
    ds_read_b64_tr_b16 v[218:219], v17 offset:29728
    ds_read_b128 v[156:159], v14 offset:32768
    v_mfma_f32_16x16x32_bf16 v[232:235], v[200:203], v[200:203], v[232:235]
    v_mfma_f32_32x32x16_bf16 v[20:35], v[88:91], v[84:87], v[20:35]
    ds_read_b128 v[160:163], v14 offset:33792
    v_mfma_f32_16x16x32_bf16 v[240:243], v[252:255], v[200:203], v[240:243]
    v_mfma_f32_32x32x16_bf16 v[36:51], v[108:111], v[100:103], v[36:51]
    ds_read_b64_tr_b16 v[164:165], v11 offset:36864
    ds_read_b64_tr_b16 v[166:167], v11 offset:37888
    ds_read_b128 v[168:171], v14 offset:34816
    v_mfma_f32_32x32x16_bf16 v[52:67], v[112:115], v[100:103], v[52:67]
    ds_read_b64_tr_b16 v[220:221], v17 offset:36864
    ds_read_b64_tr_b16 v[222:223], v17 offset:37888
    ds_read_b128 v[172:175], v14 offset:35840
    v_mfma_f32_16x16x32_bf16 v[228:231], v[204:207], v[204:207], v[228:231]
    v_mfma_f32_32x32x16_bf16 v[20:35], v[104:107], v[100:103], v[20:35]
    ds_read_b128 v[176:179], v14 offset:36864
    v_mfma_f32_16x16x32_bf16 v[236:239], v[252:255], v[204:207], v[236:239]
    v_mfma_f32_32x32x16_bf16 v[36:51], v[124:127], v[116:119], v[36:51]
    ds_read_b64_tr_b16 v[180:181], v11 offset:40960
    ds_read_b64_tr_b16 v[182:183], v11 offset:41984
    ds_read_b128 v[184:187], v14 offset:37888
    v_mfma_f32_32x32x16_bf16 v[52:67], v[128:131], v[116:119], v[52:67]
    ds_read_b64_tr_b16 v[224:225], v17 offset:36896
    ds_read_b64_tr_b16 v[226:227], v17 offset:37920
    ds_read_b128 v[188:191], v14 offset:38912
    v_mfma_f32_16x16x32_bf16 v[232:235], v[208:211], v[208:211], v[232:235]
    v_mfma_f32_32x32x16_bf16 v[20:35], v[120:123], v[116:119], v[20:35]
    ds_read_b128 v[192:195], v14 offset:39936
    v_mfma_f32_16x16x32_bf16 v[240:243], v[252:255], v[208:211], v[240:243]
    s_waitcnt lgkmcnt(0)
    s_barrier
    v_mfma_f32_32x32x16_bf16 v[36:51], v[140:143], v[132:135], v[36:51]
    ds_read_b64_tr_b16 v[68:69], v12 offset:0
    ds_read_b64_tr_b16 v[70:71], v12 offset:1024
    ds_read_b128 v[72:75], v15 offset:0
    v_mfma_f32_32x32x16_bf16 v[52:67], v[144:147], v[132:135], v[52:67]
    ds_read_b64_tr_b16 v[196:197], v19 offset:0
    ds_read_b64_tr_b16 v[198:199], v19 offset:1024
    ds_read_b128 v[76:79], v15 offset:1024
    v_mfma_f32_16x16x32_bf16 v[228:231], v[212:215], v[212:215], v[228:231]
    v_mfma_f32_32x32x16_bf16 v[20:35], v[136:139], v[132:135], v[20:35]
    ds_read_b128 v[80:83], v15 offset:2048
    v_mfma_f32_16x16x32_bf16 v[236:239], v[252:255], v[212:215], v[236:239]
    v_mfma_f32_32x32x16_bf16 v[36:51], v[156:159], v[148:151], v[36:51]
    ds_read_b64_tr_b16 v[84:85], v12 offset:4096
    ds_read_b64_tr_b16 v[86:87], v12 offset:5120
    ds_read_b128 v[88:91], v15 offset:3072
    v_mfma_f32_32x32x16_bf16 v[52:67], v[160:163], v[148:151], v[52:67]
    ds_read_b64_tr_b16 v[200:201], v19 offset:32
    ds_read_b64_tr_b16 v[202:203], v19 offset:1056
    ds_read_b128 v[92:95], v15 offset:4096
    v_mfma_f32_16x16x32_bf16 v[232:235], v[216:219], v[216:219], v[232:235]
    v_mfma_f32_32x32x16_bf16 v[20:35], v[152:155], v[148:151], v[20:35]
    ds_read_b128 v[96:99], v15 offset:5120
    v_mfma_f32_16x16x32_bf16 v[240:243], v[252:255], v[216:219], v[240:243]
    v_mfma_f32_32x32x16_bf16 v[36:51], v[172:175], v[164:167], v[36:51]
    ds_read_b64_tr_b16 v[100:101], v12 offset:8192
    ds_read_b64_tr_b16 v[102:103], v12 offset:9216
    ds_read_b128 v[104:107], v15 offset:6144
    v_mfma_f32_32x32x16_bf16 v[52:67], v[176:179], v[164:167], v[52:67]
    ds_read_b64_tr_b16 v[204:205], v19 offset:8192
    ds_read_b64_tr_b16 v[206:207], v19 offset:9216
    ds_read_b128 v[108:111], v15 offset:7168
    v_mfma_f32_16x16x32_bf16 v[228:231], v[220:223], v[220:223], v[228:231]
    v_mfma_f32_32x32x16_bf16 v[20:35], v[168:171], v[164:167], v[20:35]
    ds_read_b128 v[112:115], v15 offset:8192
    v_mfma_f32_16x16x32_bf16 v[236:239], v[252:255], v[220:223], v[236:239]
    v_mfma_f32_32x32x16_bf16 v[36:51], v[188:191], v[180:183], v[36:51]
    ds_read_b64_tr_b16 v[116:117], v12 offset:12288
    ds_read_b64_tr_b16 v[118:119], v12 offset:13312
    ds_read_b128 v[120:123], v15 offset:9216
    v_mfma_f32_32x32x16_bf16 v[52:67], v[192:195], v[180:183], v[52:67]
    ds_read_b64_tr_b16 v[208:209], v19 offset:8224
    ds_read_b64_tr_b16 v[210:211], v19 offset:9248
    ds_read_b128 v[124:127], v15 offset:10240
    v_mfma_f32_16x16x32_bf16 v[232:235], v[224:227], v[224:227], v[232:235]
    v_mfma_f32_32x32x16_bf16 v[20:35], v[184:187], v[180:183], v[20:35]
    ds_read_b128 v[128:131], v15 offset:11264
    v_mfma_f32_16x16x32_bf16 v[240:243], v[252:255], v[224:227], v[240:243]
    s_waitcnt lgkmcnt(0)
    s_barrier
    v_mfma_f32_32x32x16_bf16 v[36:51], v[76:79], v[68:71], v[36:51]
    ds_read_b64_tr_b16 v[132:133], v10 offset:0
    ds_read_b64_tr_b16 v[134:135], v10 offset:1024
    ds_read_b128 v[136:139], v13 offset:0
    v_mfma_f32_32x32x16_bf16 v[52:67], v[80:83], v[68:71], v[52:67]
    ds_read_b64_tr_b16 v[212:213], v16 offset:0
    ds_read_b64_tr_b16 v[214:215], v16 offset:1024
    ds_read_b128 v[140:143], v13 offset:1024
    v_mfma_f32_16x16x32_bf16 v[228:231], v[196:199], v[196:199], v[228:231]
    v_mfma_f32_32x32x16_bf16 v[20:35], v[72:75], v[68:71], v[20:35]
    ds_read_b128 v[144:147], v13 offset:2048
    v_mfma_f32_16x16x32_bf16 v[236:239], v[252:255], v[196:199], v[236:239]
    v_mfma_f32_32x32x16_bf16 v[36:51], v[92:95], v[84:87], v[36:51]
    ds_read_b64_tr_b16 v[148:149], v10 offset:4096
    ds_read_b64_tr_b16 v[150:151], v10 offset:5120
    ds_read_b128 v[152:155], v13 offset:3072
    v_mfma_f32_32x32x16_bf16 v[52:67], v[96:99], v[84:87], v[52:67]
    ds_read_b64_tr_b16 v[216:217], v16 offset:32
    ds_read_b64_tr_b16 v[218:219], v16 offset:1056
    ds_read_b128 v[156:159], v13 offset:4096
    v_mfma_f32_16x16x32_bf16 v[232:235], v[200:203], v[200:203], v[232:235]
    v_mfma_f32_32x32x16_bf16 v[20:35], v[88:91], v[84:87], v[20:35]
    ds_read_b128 v[160:163], v13 offset:5120
    v_mfma_f32_16x16x32_bf16 v[240:243], v[252:255], v[200:203], v[240:243]
    v_mfma_f32_32x32x16_bf16 v[36:51], v[108:111], v[100:103], v[36:51]
    ds_read_b64_tr_b16 v[164:165], v10 offset:8192
    ds_read_b64_tr_b16 v[166:167], v10 offset:9216
    ds_read_b128 v[168:171], v13 offset:6144
    v_mfma_f32_32x32x16_bf16 v[52:67], v[112:115], v[100:103], v[52:67]
    ds_read_b64_tr_b16 v[220:221], v16 offset:8192
    ds_read_b64_tr_b16 v[222:223], v16 offset:9216
    ds_read_b128 v[172:175], v13 offset:7168
    v_mfma_f32_16x16x32_bf16 v[228:231], v[204:207], v[204:207], v[228:231]
    v_mfma_f32_32x32x16_bf16 v[20:35], v[104:107], v[100:103], v[20:35]
    ds_read_b128 v[176:179], v13 offset:8192
    v_mfma_f32_16x16x32_bf16 v[236:239], v[252:255], v[204:207], v[236:239]
    v_mfma_f32_32x32x16_bf16 v[36:51], v[124:127], v[116:119], v[36:51]
    ds_read_b64_tr_b16 v[180:181], v10 offset:12288
    ds_read_b64_tr_b16 v[182:183], v10 offset:13312
    ds_read_b128 v[184:187], v13 offset:9216
    v_mfma_f32_32x32x16_bf16 v[52:67], v[128:131], v[116:119], v[52:67]
    ds_read_b64_tr_b16 v[224:225], v16 offset:8224
    ds_read_b64_tr_b16 v[226:227], v16 offset:9248
    ds_read_b128 v[188:191], v13 offset:10240
    v_mfma_f32_16x16x32_bf16 v[232:235], v[208:211], v[208:211], v[232:235]
    v_mfma_f32_32x32x16_bf16 v[20:35], v[120:123], v[116:119], v[20:35]
    ds_read_b128 v[192:195], v13 offset:11264
    v_mfma_f32_16x16x32_bf16 v[240:243], v[252:255], v[208:211], v[240:243]
    s_waitcnt lgkmcnt(0)
    s_barrier
    v_mfma_f32_32x32x16_bf16 v[36:51], v[140:143], v[132:135], v[36:51]
    ds_read_b64_tr_b16 v[68:69], v10 offset:28672
    ds_read_b64_tr_b16 v[70:71], v10 offset:29696
    ds_read_b128 v[72:75], v13 offset:28672
    v_mfma_f32_32x32x16_bf16 v[52:67], v[144:147], v[132:135], v[52:67]
    ds_read_b64_tr_b16 v[196:197], v16 offset:28672
    ds_read_b64_tr_b16 v[198:199], v16 offset:29696
    ds_read_b128 v[76:79], v13 offset:29696
    v_mfma_f32_16x16x32_bf16 v[228:231], v[212:215], v[212:215], v[228:231]
    v_mfma_f32_32x32x16_bf16 v[20:35], v[136:139], v[132:135], v[20:35]
    ds_read_b128 v[80:83], v13 offset:30720
    v_mfma_f32_16x16x32_bf16 v[236:239], v[252:255], v[212:215], v[236:239]
    v_mfma_f32_32x32x16_bf16 v[36:51], v[156:159], v[148:151], v[36:51]
    ds_read_b64_tr_b16 v[84:85], v10 offset:32768
    ds_read_b64_tr_b16 v[86:87], v10 offset:33792
    ds_read_b128 v[88:91], v13 offset:31744
    v_mfma_f32_32x32x16_bf16 v[52:67], v[160:163], v[148:151], v[52:67]
    ds_read_b64_tr_b16 v[200:201], v16 offset:28704
    ds_read_b64_tr_b16 v[202:203], v16 offset:29728
    ds_read_b128 v[92:95], v13 offset:32768
    v_mfma_f32_16x16x32_bf16 v[232:235], v[216:219], v[216:219], v[232:235]
    v_mfma_f32_32x32x16_bf16 v[20:35], v[152:155], v[148:151], v[20:35]
    ds_read_b128 v[96:99], v13 offset:33792
    v_mfma_f32_16x16x32_bf16 v[240:243], v[252:255], v[216:219], v[240:243]
    v_mfma_f32_32x32x16_bf16 v[36:51], v[172:175], v[164:167], v[36:51]
    ds_read_b64_tr_b16 v[100:101], v10 offset:36864
    ds_read_b64_tr_b16 v[102:103], v10 offset:37888
    ds_read_b128 v[104:107], v13 offset:34816
    v_mfma_f32_32x32x16_bf16 v[52:67], v[176:179], v[164:167], v[52:67]
    ds_read_b64_tr_b16 v[204:205], v16 offset:36864
    ds_read_b64_tr_b16 v[206:207], v16 offset:37888
    ds_read_b128 v[108:111], v13 offset:35840
    v_mfma_f32_16x16x32_bf16 v[228:231], v[220:223], v[220:223], v[228:231]
    v_mfma_f32_32x32x16_bf16 v[20:35], v[168:171], v[164:167], v[20:35]
    ds_read_b128 v[112:115], v13 offset:36864
    v_mfma_f32_16x16x32_bf16 v[236:239], v[252:255], v[220:223], v[236:239]
    v_mfma_f32_32x32x16_bf16 v[36:51], v[188:191], v[180:183], v[36:51]
    ds_read_b64_tr_b16 v[116:117], v10 offset:40960
    ds_read_b64_tr_b16 v[118:119], v10 offset:41984
    ds_read_b128 v[120:123], v13 offset:37888
    v_mfma_f32_32x32x16_bf16 v[52:67], v[192:195], v[180:183], v[52:67]
    ds_read_b64_tr_b16 v[208:209], v16 offset:36896
    ds_read_b64_tr_b16 v[210:211], v16 offset:37920
    ds_read_b128 v[124:127], v13 offset:38912
    v_mfma_f32_16x16x32_bf16 v[232:235], v[224:227], v[224:227], v[232:235]
    v_mfma_f32_32x32x16_bf16 v[20:35], v[184:187], v[180:183], v[20:35]
    ds_read_b128 v[128:131], v13 offset:39936
    v_mfma_f32_16x16x32_bf16 v[240:243], v[252:255], v[224:227], v[240:243]
    s_waitcnt lgkmcnt(0)
    s_barrier
    v_mfma_f32_32x32x16_bf16 v[36:51], v[76:79], v[68:71], v[36:51]
    ds_read_b64_tr_b16 v[132:133], v11 offset:0
    ds_read_b64_tr_b16 v[134:135], v11 offset:1024
    ds_read_b128 v[136:139], v14 offset:0
    v_mfma_f32_32x32x16_bf16 v[52:67], v[80:83], v[68:71], v[52:67]
    ds_read_b64_tr_b16 v[212:213], v17 offset:0
    ds_read_b64_tr_b16 v[214:215], v17 offset:1024
    ds_read_b128 v[140:143], v14 offset:1024
    v_mfma_f32_16x16x32_bf16 v[228:231], v[196:199], v[196:199], v[228:231]
    v_mfma_f32_32x32x16_bf16 v[20:35], v[72:75], v[68:71], v[20:35]
    ds_read_b128 v[144:147], v14 offset:2048
    v_mfma_f32_16x16x32_bf16 v[236:239], v[252:255], v[196:199], v[236:239]
    buffer_store_dwordx4 v[244:247], v3, s[20:23], s54 offen offset:0 sc1
    v_mfma_f32_32x32x16_bf16 v[36:51], v[92:95], v[84:87], v[36:51]
    ds_read_b64_tr_b16 v[148:149], v11 offset:4096
    ds_read_b64_tr_b16 v[150:151], v11 offset:5120
    ds_read_b128 v[152:155], v14 offset:3072
    v_mfma_f32_32x32x16_bf16 v[52:67], v[96:99], v[84:87], v[52:67]
    ds_read_b64_tr_b16 v[216:217], v17 offset:32
    ds_read_b64_tr_b16 v[218:219], v17 offset:1056
    ds_read_b128 v[156:159], v14 offset:4096
    v_mfma_f32_16x16x32_bf16 v[232:235], v[200:203], v[200:203], v[232:235]
    v_mfma_f32_32x32x16_bf16 v[20:35], v[88:91], v[84:87], v[20:35]
    ds_read_b128 v[160:163], v14 offset:5120
    v_mfma_f32_16x16x32_bf16 v[240:243], v[252:255], v[200:203], v[240:243]
    buffer_store_dwordx4 v[248:251], v3, s[20:23], s54 offen offset:1024 sc1
    v_mfma_f32_32x32x16_bf16 v[36:51], v[108:111], v[100:103], v[36:51]
    ds_read_b64_tr_b16 v[164:165], v11 offset:8192
    ds_read_b64_tr_b16 v[166:167], v11 offset:9216
    ds_read_b128 v[168:171], v14 offset:6144
    v_mfma_f32_32x32x16_bf16 v[52:67], v[112:115], v[100:103], v[52:67]
    ds_read_b64_tr_b16 v[220:221], v17 offset:8192
    ds_read_b64_tr_b16 v[222:223], v17 offset:9216
    ds_read_b128 v[172:175], v14 offset:7168
    v_mfma_f32_16x16x32_bf16 v[228:231], v[204:207], v[204:207], v[228:231]
    v_mfma_f32_32x32x16_bf16 v[20:35], v[104:107], v[100:103], v[20:35]
    ds_read_b128 v[176:179], v14 offset:8192
    v_mfma_f32_16x16x32_bf16 v[236:239], v[252:255], v[204:207], v[236:239]
    v_mfma_f32_32x32x16_bf16 v[36:51], v[124:127], v[116:119], v[36:51]
    ds_read_b64_tr_b16 v[180:181], v11 offset:12288
    ds_read_b64_tr_b16 v[182:183], v11 offset:13312
    ds_read_b128 v[184:187], v14 offset:9216
    v_mfma_f32_32x32x16_bf16 v[52:67], v[128:131], v[116:119], v[52:67]
    ds_read_b64_tr_b16 v[224:225], v17 offset:8224
    ds_read_b64_tr_b16 v[226:227], v17 offset:9248
    ds_read_b128 v[188:191], v14 offset:10240
    v_mfma_f32_16x16x32_bf16 v[232:235], v[208:211], v[208:211], v[232:235]
    v_mfma_f32_32x32x16_bf16 v[20:35], v[120:123], v[116:119], v[20:35]
    ds_read_b128 v[192:195], v14 offset:11264
    v_mfma_f32_16x16x32_bf16 v[240:243], v[252:255], v[208:211], v[240:243]
    s_waitcnt lgkmcnt(0)
    v_mfma_f32_32x32x16_bf16 v[36:51], v[140:143], v[132:135], v[36:51]
    v_mfma_f32_32x32x16_bf16 v[52:67], v[144:147], v[132:135], v[52:67]
    v_mfma_f32_16x16x32_bf16 v[228:231], v[212:215], v[212:215], v[228:231]
    v_mfma_f32_32x32x16_bf16 v[20:35], v[136:139], v[132:135], v[20:35]
    v_mfma_f32_16x16x32_bf16 v[236:239], v[252:255], v[212:215], v[236:239]
    v_mfma_f32_32x32x16_bf16 v[36:51], v[156:159], v[148:151], v[36:51]
    v_mfma_f32_32x32x16_bf16 v[52:67], v[160:163], v[148:151], v[52:67]
    v_mfma_f32_16x16x32_bf16 v[232:235], v[216:219], v[216:219], v[232:235]
    v_mfma_f32_32x32x16_bf16 v[20:35], v[152:155], v[148:151], v[20:35]
    v_mfma_f32_16x16x32_bf16 v[240:243], v[252:255], v[216:219], v[240:243]
    v_mfma_f32_32x32x16_bf16 v[36:51], v[172:175], v[164:167], v[36:51]
    v_mfma_f32_32x32x16_bf16 v[52:67], v[176:179], v[164:167], v[52:67]
    v_mfma_f32_16x16x32_bf16 v[228:231], v[220:223], v[220:223], v[228:231]
    v_mfma_f32_32x32x16_bf16 v[20:35], v[168:171], v[164:167], v[20:35]
    v_mfma_f32_16x16x32_bf16 v[236:239], v[252:255], v[220:223], v[236:239]
    v_mfma_f32_32x32x16_bf16 v[36:51], v[188:191], v[180:183], v[36:51]
    v_mfma_f32_32x32x16_bf16 v[52:67], v[192:195], v[180:183], v[52:67]
    v_mfma_f32_16x16x32_bf16 v[232:235], v[224:227], v[224:227], v[232:235]
    v_mfma_f32_32x32x16_bf16 v[20:35], v[184:187], v[180:183], v[20:35]
    v_mfma_f32_16x16x32_bf16 v[240:243], v[252:255], v[224:227], v[240:243]
    v_and_b32 v4, 3, v2
    v_cmp_eq_u32 s[60:61], 1, v4
    v_cmp_eq_u32 s[62:63], 2, v4
    v_cmp_eq_u32 vcc, 3, v4
    v_bfe_u32 v5, v2, 2, 2
    v_lshrrev_b32 v6, 4, v2
    v_cmp_eq_u32 s[58:59], v5, v6
    s_lshl_b32 s57, s41, 7
    s_add_u32 s57, s57, 86016
    v_and_b32 v5, 15, v2
    v_lshl_add_u32 v5, v5, 2, s57
    v_lshl_add_u32 v6, v8, 2, s57
    s_nop 3
    v_cndmask_b32 v228, v228, v229, s[60:61]
    v_cndmask_b32 v228, v228, v230, s[62:63]
    v_cndmask_b32 v228, v228, v231, vcc
    v_cndmask_b32 v232, v232, v233, s[60:61]
    v_cndmask_b32 v232, v232, v234, s[62:63]
    v_cndmask_b32 v232, v232, v235, vcc
    v_and_b32 v4, 16, v2
    v_cmp_eq_u32 vcc, 0, v4
    s_mov_b64 exec, s[58:59]
    ds_write_b32 v5, v228
    ds_write_b32 v5, v232 offset:64
    s_mov_b64 exec, -1
    v_cndmask_b32 v10, v240, v236, vcc
    ds_read_b32 v11, v6
    ds_read_b128 v[228:231], v9 offset:256
    ds_read_b128 v[232:235], v9 offset:272
    ds_read_b128 v[236:239], v9 offset:288
    ds_read_b128 v[240:243], v9 offset:304
    ds_read_b128 v[212:215], v9 offset:128
    ds_read_b128 v[216:219], v9 offset:144
    ds_read_b128 v[220:223], v9 offset:160
    ds_read_b128 v[224:227], v9 offset:176
    ds_read_b128 v[196:199], v9 offset:0
    ds_read_b128 v[200:203], v9 offset:16
    ds_read_b128 v[204:207], v9 offset:32
    ds_read_b128 v[208:211], v9 offset:48
    v_mov_b32 v18, 0x3f803f80
    s_waitcnt lgkmcnt(12)
    v_mul_f32 v10, 0x3b000000, v10
    v_mul_f32 v11, 0x3b000000, v11
    v_fma_f32 v11, -v10, v10, v11
    v_max_f32 v11, 0, v11
    v_add_f32 v11, 0x3727c5ac, v11
    v_rsq_f32 v12, v11
    s_mul_i32 s55, s41, 10752
    v_mul_u32_u24 v4, 336, v8
    v_lshl_add_u32 v4, v7, 6, v4
    v_add_u32 v4, s55, v4
    v_mul_f32 v14, 0x3fb8aa3b, v12
    s_waitcnt lgkmcnt(0)
    v_pk_fma_f32 v[52:53], v[228:229], v[10:11], v[52:53] op_sel_hi:[1,0,1] neg_lo:[0,1,0] neg_hi:[0,1,0]
    v_pk_fma_f32 v[54:55], v[230:231], v[10:11], v[54:55] op_sel_hi:[1,0,1] neg_lo:[0,1,0] neg_hi:[0,1,0]
    v_pk_fma_f32 v[56:57], v[232:233], v[10:11], v[56:57] op_sel_hi:[1,0,1] neg_lo:[0,1,0] neg_hi:[0,1,0]
    v_pk_fma_f32 v[58:59], v[234:235], v[10:11], v[58:59] op_sel_hi:[1,0,1] neg_lo:[0,1,0] neg_hi:[0,1,0]
    v_pk_fma_f32 v[60:61], v[236:237], v[10:11], v[60:61] op_sel_hi:[1,0,1] neg_lo:[0,1,0] neg_hi:[0,1,0]
    v_pk_fma_f32 v[62:63], v[238:239], v[10:11], v[62:63] op_sel_hi:[1,0,1] neg_lo:[0,1,0] neg_hi:[0,1,0]
    v_pk_fma_f32 v[64:65], v[240:241], v[10:11], v[64:65] op_sel_hi:[1,0,1] neg_lo:[0,1,0] neg_hi:[0,1,0]
    v_pk_fma_f32 v[66:67], v[242:243], v[10:11], v[66:67] op_sel_hi:[1,0,1] neg_lo:[0,1,0] neg_hi:[0,1,0]
    v_pk_mul_f32 v[52:53], v[52:53], v[12:13] op_sel_hi:[1,0]
    v_pk_mul_f32 v[54:55], v[54:55], v[12:13] op_sel_hi:[1,0]
    v_pk_mul_f32 v[56:57], v[56:57], v[12:13] op_sel_hi:[1,0]
    v_pk_mul_f32 v[58:59], v[58:59], v[12:13] op_sel_hi:[1,0]
    v_pk_mul_f32 v[60:61], v[60:61], v[12:13] op_sel_hi:[1,0]
    v_pk_mul_f32 v[62:63], v[62:63], v[12:13] op_sel_hi:[1,0]
    v_pk_mul_f32 v[64:65], v[64:65], v[12:13] op_sel_hi:[1,0]
    v_pk_mul_f32 v[66:67], v[66:67], v[12:13] op_sel_hi:[1,0]
    v_cvt_pk_bf16_f32 v128, v52, v53
    v_cvt_pk_bf16_f32 v129, v54, v55
    v_cvt_pk_bf16_f32 v130, v56, v57
    v_cvt_pk_bf16_f32 v131, v58, v59
    v_cvt_pk_bf16_f32 v132, v60, v61
    v_cvt_pk_bf16_f32 v133, v62, v63
    v_cvt_pk_bf16_f32 v134, v64, v65
    v_cvt_pk_bf16_f32 v135, v66, v67
    v_mov_b32 v136, v18
    v_mov_b32 v137, v18
    v_mov_b32 v138, v18
    v_mov_b32 v139, v18
    ds_write_b128 v4, v[128:131] offset:128
    ds_write_b128 v4, v[132:135] offset:144
    ds_write_b128 v4, v[136:139] offset:160
    ds_write_b128 v4, v[136:139] offset:176
    v_pk_fma_f32 v[36:37], v[212:213], v[10:11], v[36:37] op_sel_hi:[1,0,1] neg_lo:[0,1,0] neg_hi:[0,1,0]
    v_pk_fma_f32 v[38:39], v[214:215], v[10:11], v[38:39] op_sel_hi:[1,0,1] neg_lo:[0,1,0] neg_hi:[0,1,0]
    v_pk_fma_f32 v[40:41], v[216:217], v[10:11], v[40:41] op_sel_hi:[1,0,1] neg_lo:[0,1,0] neg_hi:[0,1,0]
    v_pk_fma_f32 v[42:43], v[218:219], v[10:11], v[42:43] op_sel_hi:[1,0,1] neg_lo:[0,1,0] neg_hi:[0,1,0]
    v_pk_fma_f32 v[44:45], v[220:221], v[10:11], v[44:45] op_sel_hi:[1,0,1] neg_lo:[0,1,0] neg_hi:[0,1,0]
    v_pk_fma_f32 v[46:47], v[222:223], v[10:11], v[46:47] op_sel_hi:[1,0,1] neg_lo:[0,1,0] neg_hi:[0,1,0]
    v_pk_fma_f32 v[48:49], v[224:225], v[10:11], v[48:49] op_sel_hi:[1,0,1] neg_lo:[0,1,0] neg_hi:[0,1,0]
    v_pk_fma_f32 v[50:51], v[226:227], v[10:11], v[50:51] op_sel_hi:[1,0,1] neg_lo:[0,1,0] neg_hi:[0,1,0]
    v_max3_f32 v100, v36, v37, v38
    v_min3_f32 v102, v36, v37, v38
    v_max3_f32 v100, v100, v39, v40
    v_min3_f32 v102, v102, v39, v40
    v_max3_f32 v100, v100, v41, v42
    v_min3_f32 v102, v102, v41, v42
    v_max3_f32 v100, v100, v43, v44
    v_min3_f32 v102, v102, v43, v44
    v_max3_f32 v100, v100, v45, v46
    v_min3_f32 v102, v102, v45, v46
    v_max3_f32 v100, v100, v47, v48
    v_min3_f32 v102, v102, v47, v48
    v_max3_f32 v100, v100, v49, v50
    v_min3_f32 v102, v102, v49, v50
    v_max_f32 v100, v100, v51
    v_min_f32 v102, v102, v51
    v_mul_f32 v100, v100, v14
    v_mul_f32 v102, v102, v14
    v_pk_fma_f32 v[68:69], v[36:37], v[14:15], v[100:101] op_sel_hi:[1,0,0] neg_lo:[0,0,1] neg_hi:[0,0,1]
    v_pk_fma_f32 v[84:85], v[36:37], v[14:15], v[102:103] op_sel_hi:[1,0,0] neg_lo:[1,0,0] neg_hi:[1,0,0]
    v_pk_fma_f32 v[70:71], v[38:39], v[14:15], v[100:101] op_sel_hi:[1,0,0] neg_lo:[0,0,1] neg_hi:[0,0,1]
    v_pk_fma_f32 v[86:87], v[38:39], v[14:15], v[102:103] op_sel_hi:[1,0,0] neg_lo:[1,0,0] neg_hi:[1,0,0]
    v_pk_fma_f32 v[72:73], v[40:41], v[14:15], v[100:101] op_sel_hi:[1,0,0] neg_lo:[0,0,1] neg_hi:[0,0,1]
    v_pk_fma_f32 v[88:89], v[40:41], v[14:15], v[102:103] op_sel_hi:[1,0,0] neg_lo:[1,0,0] neg_hi:[1,0,0]
    v_pk_fma_f32 v[74:75], v[42:43], v[14:15], v[100:101] op_sel_hi:[1,0,0] neg_lo:[0,0,1] neg_hi:[0,0,1]
    v_pk_fma_f32 v[90:91], v[42:43], v[14:15], v[102:103] op_sel_hi:[1,0,0] neg_lo:[1,0,0] neg_hi:[1,0,0]
    v_pk_fma_f32 v[76:77], v[44:45], v[14:15], v[100:101] op_sel_hi:[1,0,0] neg_lo:[0,0,1] neg_hi:[0,0,1]
    v_pk_fma_f32 v[92:93], v[44:45], v[14:15], v[102:103] op_sel_hi:[1,0,0] neg_lo:[1,0,0] neg_hi:[1,0,0]
    v_pk_fma_f32 v[78:79], v[46:47], v[14:15], v[100:101] op_sel_hi:[1,0,0] neg_lo:[0,0,1] neg_hi:[0,0,1]
    v_pk_fma_f32 v[94:95], v[46:47], v[14:15], v[102:103] op_sel_hi:[1,0,0] neg_lo:[1,0,0] neg_hi:[1,0,0]
    v_pk_fma_f32 v[80:81], v[48:49], v[14:15], v[100:101] op_sel_hi:[1,0,0] neg_lo:[0,0,1] neg_hi:[0,0,1]
    v_pk_fma_f32 v[96:97], v[48:49], v[14:15], v[102:103] op_sel_hi:[1,0,0] neg_lo:[1,0,0] neg_hi:[1,0,0]
    v_pk_fma_f32 v[82:83], v[50:51], v[14:15], v[100:101] op_sel_hi:[1,0,0] neg_lo:[0,0,1] neg_hi:[0,0,1]
    v_pk_fma_f32 v[98:99], v[50:51], v[14:15], v[102:103] op_sel_hi:[1,0,0] neg_lo:[1,0,0] neg_hi:[1,0,0]
    v_exp_f32 v68, v68
    v_exp_f32 v69, v69
    v_exp_f32 v70, v70
    v_exp_f32 v71, v71
    v_exp_f32 v72, v72
    v_exp_f32 v73, v73
    v_exp_f32 v74, v74
    v_exp_f32 v75, v75
    v_exp_f32 v76, v76
    v_exp_f32 v77, v77
    v_exp_f32 v78, v78
    v_exp_f32 v79, v79
    v_exp_f32 v80, v80
    v_exp_f32 v81, v81
    v_exp_f32 v82, v82
    v_exp_f32 v83, v83
    v_exp_f32 v84, v84
    v_exp_f32 v85, v85
    v_exp_f32 v86, v86
    v_exp_f32 v87, v87
    v_exp_f32 v88, v88
    v_exp_f32 v89, v89
    v_exp_f32 v90, v90
    v_exp_f32 v91, v91
    v_exp_f32 v92, v92
    v_exp_f32 v93, v93
    v_exp_f32 v94, v94
    v_exp_f32 v95, v95
    v_exp_f32 v96, v96
    v_exp_f32 v97, v97
    v_exp_f32 v98, v98
    v_exp_f32 v99, v99
    v_pk_add_f32 v[100:101], v[68:69], v[70:71]
    v_pk_add_f32 v[102:103], v[84:85], v[86:87]
    v_pk_add_f32 v[100:101], v[100:101], v[72:73]
    v_pk_add_f32 v[102:103], v[102:103], v[88:89]
    v_pk_add_f32 v[100:101], v[100:101], v[74:75]
    v_pk_add_f32 v[102:103], v[102:103], v[90:91]
    v_pk_add_f32 v[100:101], v[100:101], v[76:77]
    v_pk_add_f32 v[102:103], v[102:103], v[92:93]
    v_pk_add_f32 v[100:101], v[100:101], v[78:79]
    v_pk_add_f32 v[102:103], v[102:103], v[94:95]
    v_pk_add_f32 v[100:101], v[100:101], v[80:81]
    v_pk_add_f32 v[102:103], v[102:103], v[96:97]
    v_pk_add_f32 v[100:101], v[100:101], v[82:83]
    v_pk_add_f32 v[102:103], v[102:103], v[98:99]
    v_add_f32 v100, v100, v101
    v_add_f32 v102, v102, v103
    v_rcp_f32 v100, v100
    v_rcp_f32 v102, v102
    s_nop 0
    v_pk_mul_f32 v[68:69], v[68:69], v[100:101] op_sel_hi:[1,0]
    v_pk_mul_f32 v[84:85], v[84:85], v[102:103] op_sel_hi:[1,0]
    v_pk_mul_f32 v[70:71], v[70:71], v[100:101] op_sel_hi:[1,0]
    v_pk_mul_f32 v[86:87], v[86:87], v[102:103] op_sel_hi:[1,0]
    v_pk_mul_f32 v[72:73], v[72:73], v[100:101] op_sel_hi:[1,0]
    v_pk_mul_f32 v[88:89], v[88:89], v[102:103] op_sel_hi:[1,0]
    v_pk_mul_f32 v[74:75], v[74:75], v[100:101] op_sel_hi:[1,0]
    v_pk_mul_f32 v[90:91], v[90:91], v[102:103] op_sel_hi:[1,0]
    v_pk_mul_f32 v[76:77], v[76:77], v[100:101] op_sel_hi:[1,0]
    v_pk_mul_f32 v[92:93], v[92:93], v[102:103] op_sel_hi:[1,0]
    v_pk_mul_f32 v[78:79], v[78:79], v[100:101] op_sel_hi:[1,0]
    v_pk_mul_f32 v[94:95], v[94:95], v[102:103] op_sel_hi:[1,0]
    v_pk_mul_f32 v[80:81], v[80:81], v[100:101] op_sel_hi:[1,0]
    v_pk_mul_f32 v[96:97], v[96:97], v[102:103] op_sel_hi:[1,0]
    v_pk_mul_f32 v[82:83], v[82:83], v[100:101] op_sel_hi:[1,0]
    v_pk_mul_f32 v[98:99], v[98:99], v[102:103] op_sel_hi:[1,0]
    v_cvt_pk_bf16_f32 v112, v68, v69
    v_cvt_pk_bf16_f32 v113, v70, v71
    v_cvt_pk_bf16_f32 v114, v72, v73
    v_cvt_pk_bf16_f32 v115, v74, v75
    v_cvt_pk_bf16_f32 v116, v76, v77
    v_cvt_pk_bf16_f32 v117, v78, v79
    v_cvt_pk_bf16_f32 v118, v80, v81
    v_cvt_pk_bf16_f32 v119, v82, v83
    v_cvt_pk_bf16_f32 v120, v84, v85
    v_cvt_pk_bf16_f32 v121, v86, v87
    v_cvt_pk_bf16_f32 v122, v88, v89
    v_cvt_pk_bf16_f32 v123, v90, v91
    v_cvt_pk_bf16_f32 v124, v92, v93
    v_cvt_pk_bf16_f32 v125, v94, v95
    v_cvt_pk_bf16_f32 v126, v96, v97
    v_cvt_pk_bf16_f32 v127, v98, v99
    ds_write_b128 v4, v[112:115] offset:0
    ds_write_b128 v4, v[116:119] offset:16
    ds_write_b128 v4, v[120:123] offset:32
    ds_write_b128 v4, v[124:127] offset:48
    s_waitcnt lgkmcnt(0)
    s_barrier
    v_pk_fma_f32 v[20:21], v[196:197], v[10:11], v[20:21] op_sel_hi:[1,0,1] neg_lo:[0,1,0] neg_hi:[0,1,0]
    v_pk_fma_f32 v[22:23], v[198:199], v[10:11], v[22:23] op_sel_hi:[1,0,1] neg_lo:[0,1,0] neg_hi:[0,1,0]
    v_pk_fma_f32 v[24:25], v[200:201], v[10:11], v[24:25] op_sel_hi:[1,0,1] neg_lo:[0,1,0] neg_hi:[0,1,0]
    v_pk_fma_f32 v[26:27], v[202:203], v[10:11], v[26:27] op_sel_hi:[1,0,1] neg_lo:[0,1,0] neg_hi:[0,1,0]
    v_pk_fma_f32 v[28:29], v[204:205], v[10:11], v[28:29] op_sel_hi:[1,0,1] neg_lo:[0,1,0] neg_hi:[0,1,0]
    v_pk_fma_f32 v[30:31], v[206:207], v[10:11], v[30:31] op_sel_hi:[1,0,1] neg_lo:[0,1,0] neg_hi:[0,1,0]
    v_pk_fma_f32 v[32:33], v[208:209], v[10:11], v[32:33] op_sel_hi:[1,0,1] neg_lo:[0,1,0] neg_hi:[0,1,0]
    v_pk_fma_f32 v[34:35], v[210:211], v[10:11], v[34:35] op_sel_hi:[1,0,1] neg_lo:[0,1,0] neg_hi:[0,1,0]
    v_max3_f32 v100, v20, v21, v22
    v_min3_f32 v102, v20, v21, v22
    v_max3_f32 v100, v100, v23, v24
    v_min3_f32 v102, v102, v23, v24
    v_max3_f32 v100, v100, v25, v26
    v_min3_f32 v102, v102, v25, v26
    v_max3_f32 v100, v100, v27, v28
    v_min3_f32 v102, v102, v27, v28
    v_max3_f32 v100, v100, v29, v30
    v_min3_f32 v102, v102, v29, v30
    v_max3_f32 v100, v100, v31, v32
    v_min3_f32 v102, v102, v31, v32
    v_max3_f32 v100, v100, v33, v34
    v_min3_f32 v102, v102, v33, v34
    v_max_f32 v100, v100, v35
    v_min_f32 v102, v102, v35
    v_mul_f32 v100, v100, v14
    v_mul_f32 v102, v102, v14
    v_pk_fma_f32 v[68:69], v[20:21], v[14:15], v[100:101] op_sel_hi:[1,0,0] neg_lo:[0,0,1] neg_hi:[0,0,1]
    v_pk_fma_f32 v[84:85], v[20:21], v[14:15], v[102:103] op_sel_hi:[1,0,0] neg_lo:[1,0,0] neg_hi:[1,0,0]
    v_pk_fma_f32 v[70:71], v[22:23], v[14:15], v[100:101] op_sel_hi:[1,0,0] neg_lo:[0,0,1] neg_hi:[0,0,1]
    v_pk_fma_f32 v[86:87], v[22:23], v[14:15], v[102:103] op_sel_hi:[1,0,0] neg_lo:[1,0,0] neg_hi:[1,0,0]
    v_pk_fma_f32 v[72:73], v[24:25], v[14:15], v[100:101] op_sel_hi:[1,0,0] neg_lo:[0,0,1] neg_hi:[0,0,1]
    v_pk_fma_f32 v[88:89], v[24:25], v[14:15], v[102:103] op_sel_hi:[1,0,0] neg_lo:[1,0,0] neg_hi:[1,0,0]
    v_pk_fma_f32 v[74:75], v[26:27], v[14:15], v[100:101] op_sel_hi:[1,0,0] neg_lo:[0,0,1] neg_hi:[0,0,1]
    v_pk_fma_f32 v[90:91], v[26:27], v[14:15], v[102:103] op_sel_hi:[1,0,0] neg_lo:[1,0,0] neg_hi:[1,0,0]
    v_pk_fma_f32 v[76:77], v[28:29], v[14:15], v[100:101] op_sel_hi:[1,0,0] neg_lo:[0,0,1] neg_hi:[0,0,1]
    v_pk_fma_f32 v[92:93], v[28:29], v[14:15], v[102:103] op_sel_hi:[1,0,0] neg_lo:[1,0,0] neg_hi:[1,0,0]
    v_pk_fma_f32 v[78:79], v[30:31], v[14:15], v[100:101] op_sel_hi:[1,0,0] neg_lo:[0,0,1] neg_hi:[0,0,1]
    v_pk_fma_f32 v[94:95], v[30:31], v[14:15], v[102:103] op_sel_hi:[1,0,0] neg_lo:[1,0,0] neg_hi:[1,0,0]
    v_pk_fma_f32 v[80:81], v[32:33], v[14:15], v[100:101] op_sel_hi:[1,0,0] neg_lo:[0,0,1] neg_hi:[0,0,1]
    v_pk_fma_f32 v[96:97], v[32:33], v[14:15], v[102:103] op_sel_hi:[1,0,0] neg_lo:[1,0,0] neg_hi:[1,0,0]
    v_pk_fma_f32 v[82:83], v[34:35], v[14:15], v[100:101] op_sel_hi:[1,0,0] neg_lo:[0,0,1] neg_hi:[0,0,1]
    v_pk_fma_f32 v[98:99], v[34:35], v[14:15], v[102:103] op_sel_hi:[1,0,0] neg_lo:[1,0,0] neg_hi:[1,0,0]
    v_exp_f32 v68, v68
    v_exp_f32 v69, v69
    v_exp_f32 v70, v70
    v_exp_f32 v71, v71
    v_exp_f32 v72, v72
    v_exp_f32 v73, v73
    v_exp_f32 v74, v74
    v_exp_f32 v75, v75
    v_exp_f32 v76, v76
    v_exp_f32 v77, v77
    v_exp_f32 v78, v78
    v_exp_f32 v79, v79
    v_exp_f32 v80, v80
    v_exp_f32 v81, v81
    v_exp_f32 v82, v82
    v_exp_f32 v83, v83
    v_exp_f32 v84, v84
    v_exp_f32 v85, v85
    v_exp_f32 v86, v86
    v_exp_f32 v87, v87
    v_exp_f32 v88, v88
    v_exp_f32 v89, v89
    v_exp_f32 v90, v90
    v_exp_f32 v91, v91
    v_exp_f32 v92, v92
    v_exp_f32 v93, v93
    v_exp_f32 v94, v94
    v_exp_f32 v95, v95
    v_exp_f32 v96, v96
    v_exp_f32 v97, v97
    v_exp_f32 v98, v98
    v_exp_f32 v99, v99
    v_pk_add_f32 v[100:101], v[68:69], v[70:71]
    v_pk_add_f32 v[102:103], v[84:85], v[86:87]
    v_pk_add_f32 v[100:101], v[100:101], v[72:73]
    v_pk_add_f32 v[102:103], v[102:103], v[88:89]
    v_pk_add_f32 v[100:101], v[100:101], v[74:75]
    v_pk_add_f32 v[102:103], v[102:103], v[90:91]
    v_pk_add_f32 v[100:101], v[100:101], v[76:77]
    v_pk_add_f32 v[102:103], v[102:103], v[92:93]
    v_pk_add_f32 v[100:101], v[100:101], v[78:79]
    v_pk_add_f32 v[102:103], v[102:103], v[94:95]
    v_pk_add_f32 v[100:101], v[100:101], v[80:81]
    v_pk_add_f32 v[102:103], v[102:103], v[96:97]
    v_pk_add_f32 v[100:101], v[100:101], v[82:83]
    v_pk_add_f32 v[102:103], v[102:103], v[98:99]
    v_add_f32 v100, v100, v101
    v_add_f32 v102, v102, v103
    v_rcp_f32 v100, v100
    v_rcp_f32 v102, v102
    s_nop 0
    v_pk_mul_f32 v[68:69], v[68:69], v[100:101] op_sel_hi:[1,0]
    v_pk_mul_f32 v[84:85], v[84:85], v[102:103] op_sel_hi:[1,0]
    v_pk_mul_f32 v[70:71], v[70:71], v[100:101] op_sel_hi:[1,0]
    v_pk_mul_f32 v[86:87], v[86:87], v[102:103] op_sel_hi:[1,0]
    v_pk_mul_f32 v[72:73], v[72:73], v[100:101] op_sel_hi:[1,0]
    v_pk_mul_f32 v[88:89], v[88:89], v[102:103] op_sel_hi:[1,0]
    v_pk_mul_f32 v[74:75], v[74:75], v[100:101] op_sel_hi:[1,0]
    v_pk_mul_f32 v[90:91], v[90:91], v[102:103] op_sel_hi:[1,0]
    v_pk_mul_f32 v[76:77], v[76:77], v[100:101] op_sel_hi:[1,0]
    v_pk_mul_f32 v[92:93], v[92:93], v[102:103] op_sel_hi:[1,0]
    v_pk_mul_f32 v[78:79], v[78:79], v[100:101] op_sel_hi:[1,0]
    v_pk_mul_f32 v[94:95], v[94:95], v[102:103] op_sel_hi:[1,0]
    v_pk_mul_f32 v[80:81], v[80:81], v[100:101] op_sel_hi:[1,0]
    v_pk_mul_f32 v[96:97], v[96:97], v[102:103] op_sel_hi:[1,0]
    v_pk_mul_f32 v[82:83], v[82:83], v[100:101] op_sel_hi:[1,0]
    v_pk_mul_f32 v[98:99], v[98:99], v[102:103] op_sel_hi:[1,0]
    v_cvt_pk_bf16_f32 v112, v68, v69
    v_cvt_pk_bf16_f32 v113, v70, v71
    v_cvt_pk_bf16_f32 v114, v72, v73
    v_cvt_pk_bf16_f32 v115, v74, v75
    v_cvt_pk_bf16_f32 v116, v76, v77
    v_cvt_pk_bf16_f32 v117, v78, v79
    v_cvt_pk_bf16_f32 v118, v80, v81
    v_cvt_pk_bf16_f32 v119, v82, v83
    v_cvt_pk_bf16_f32 v120, v84, v85
    v_cvt_pk_bf16_f32 v121, v86, v87
    v_cvt_pk_bf16_f32 v122, v88, v89
    v_cvt_pk_bf16_f32 v123, v90, v91
    v_cvt_pk_bf16_f32 v124, v92, v93
    v_cvt_pk_bf16_f32 v125, v94, v95
    v_cvt_pk_bf16_f32 v126, v96, v97
    v_cvt_pk_bf16_f32 v127, v98, v99
    v_lshlrev_b32 v5, 4, v8
    v_lshl_add_u32 v5, v7, 11, v5
    s_lshl_b32 s55, s44, 2
    s_add_u32 s55, s55, s41
    s_lshl_b32 s55, s55, 16
    s_lshl_b32 s56, s45, 12
    s_add_u32 s55, s55, s56
    s_add_u32 s55, s55, 20971520
    buffer_store_dwordx4 v[112:115], v5, s[20:23], s55 offen offset:0 sc1
    buffer_store_dwordx4 v[116:119], v5, s[20:23], s55 offen offset:512 sc1
    buffer_store_dwordx4 v[120:123], v5, s[20:23], s55 offen offset:1024 sc1
    buffer_store_dwordx4 v[124:127], v5, s[20:23], s55 offen offset:1536 sc1
K3_DONE:
    s_endpgm
.globl proj1_kernel
.p2align 8
.type proj1_kernel,@function
proj1_kernel:
    s_cmp_ge_u32 s2, 256
    s_cbranch_scc1 K4_DONE
    s_load_dwordx2 s[18:19], s[0:1], 96
    s_load_dwordx2 s[16:17], s[0:1], 80
    v_lshrrev_b32 v1, 6, v0
    v_and_b32 v2, 63, v0
    v_readfirstlane_b32 s41, v1
    s_and_b32 s42, s2, 7
    s_lshr_b32 s43, s2, 3
    s_lshl_b32 s44, s42, 3
    s_lshr_b32 s45, s43, 2
    s_add_u32 s44, s44, s45
    s_and_b32 s45, s43, 3
    v_lshlrev_b32 v3, 4, v2
    v_lshrrev_b32 v7, 5, v2
    v_and_b32 v8, 31, v2
    v_bfe_u32 v4, v8, 2, 1
    v_bfe_u32 v5, v8, 3, 1
    v_and_b32 v6, 3, v8
    v_lshl_add_u32 v6, v5, 2, v6
    v_lshl_add_u32 v6, v4, 3, v6
    v_cmp_gt_u32 vcc, 16, v8
    v_lshlrev_b32 v9, 10, v8
    v_lshl_add_u32 v9, v7, 5, v9
    v_cndmask_b32 v6, 16, v6, vcc
    v_and_b32 v4, 7, v6
    v_lshlrev_b32 v6, 7, v6
    v_lshlrev_b32 v5, 5, v7
    s_mul_i32 s56, s41, 17408
    s_add_u32 s56, s56, 43008
    v_add_u32 v6, s56, v6
    v_lshrrev_b32 v60, 3, v2
    v_xor_b32 v60, v60, v2
    v_and_b32 v60, 7, v60
    v_and_b32 v61, 56, v2
    v_or_b32 v60, v60, v61
    v_lshlrev_b32 v63, 4, v60
    s_lshl_b32 s46, s44, 16
    s_lshl_b32 s47, s41, 14
    s_add_u32 s46, s46, s47
    s_add_u32 s46, s46, 20971520
    s_mul_i32 s47, s41, 17408
    s_add_u32 s47, s47, 25165824
    s_lshl_b32 s48, s45, 2
    s_add_u32 s48, s48, s41
    s_lshl_b32 s49, s48, 6
    s_lshl_b32 s48, s48, 15
    s_add_u32 s48, s48, 8388608
    s_lshl_b32 s50, s44, 15
    s_add_u32 s49, s49, s50
    s_lshl_b32 s51, s45, 13
    s_add_u32 s50, s50, s51
    s_lshl_b32 s51, s41, 11
    s_add_u32 s50, s50, s51
    s_add_u32 s50, s50, 15728640
    v_lshlrev_b32 v11, 5, v2
    s_lshl_b32 s51, s41, 13
    v_add_u32 v10, s51, v3
    s_waitcnt lgkmcnt(0)
    s_mov_b32 s20, s18
    s_mov_b32 s21, s19
    s_mov_b32 s22, 33554432
    s_mov_b32 s23, 0x20000
    s_mov_b32 m0, s56
    s_nop 0
    buffer_load_dwordx4 v63, s[20:23], s47 offen offset:0 lds
    buffer_load_dwordx4 v63, s[20:23], s47 offen offset:1024 lds
    buffer_load_dwordx4 v63, s[20:23], s47 offen offset:2048 lds
    buffer_load_dwordx4 v[64:67], v3, s[20:23], s46 offen offset:0
    buffer_load_dwordx4 v[68:71], v3, s[20:23], s46 offen offset:1024
    buffer_load_dwordx4 v63, s[20:23], s47 offen offset:3072 lds
    s_add_u32 s47, s47, 4096
    s_add_u32 m0, m0, 4096
    s_nop 0
    buffer_load_dwordx4 v63, s[20:23], s47 offen offset:0 lds
    buffer_load_dwordx4 v[72:75], v3, s[20:23], s46 offen offset:2048
    buffer_load_dwordx4 v[76:79], v3, s[20:23], s46 offen offset:3072
    buffer_load_dwordx4 v63, s[20:23], s47 offen offset:1024 lds
    buffer_load_dwordx4 v63, s[20:23], s47 offen offset:2048 lds
    s_add_u32 s46, s46, 4096
    buffer_load_dwordx4 v[80:83], v3, s[20:23], s46 offen offset:0
    buffer_load_dwordx4 v[84:87], v3, s[20:23], s46 offen offset:1024
    buffer_load_dwordx4 v63, s[20:23], s47 offen offset:3072 lds
    s_add_u32 s47, s47, 4096
    s_add_u32 m0, m0, 4096
    s_nop 0
    buffer_load_dwordx4 v63, s[20:23], s47 offen offset:0 lds
    buffer_load_dwordx4 v[88:91], v3, s[20:23], s46 offen offset:2048
    buffer_load_dwordx4 v[92:95], v3, s[20:23], s46 offen offset:3072
    buffer_load_dwordx4 v63, s[20:23], s47 offen offset:1024 lds
    buffer_load_dwordx4 v63, s[20:23], s47 offen offset:2048 lds
    s_add_u32 s46, s46, 4096
    buffer_load_dwordx4 v[96:99], v3, s[20:23], s46 offen offset:0
    buffer_load_dwordx4 v[100:103], v3, s[20:23], s46 offen offset:1024
    buffer_load_dwordx4 v63, s[20:23], s47 offen offset:3072 lds
    s_add_u32 s47, s47, 4096
    s_add_u32 m0, m0, 4096
    s_nop 0
    buffer_load_dwordx4 v63, s[20:23], s47 offen offset:0 lds
    buffer_load_dwordx4 v[104:107], v3, s[20:23], s46 offen offset:2048
    buffer_load_dwordx4 v[108:111], v3, s[20:23], s46 offen offset:3072
    buffer_load_dwordx4 v63, s[20:23], s47 offen offset:1024 lds
    buffer_load_dwordx4 v63, s[20:23], s47 offen offset:2048 lds
    s_add_u32 s46, s46, 4096
    buffer_load_dwordx4 v[112:115], v3, s[20:23], s46 offen offset:0
    buffer_load_dwordx4 v[116:119], v3, s[20:23], s46 offen offset:1024
    buffer_load_dwordx4 v63, s[20:23], s47 offen offset:3072 lds
    s_add_u32 s47, s47, 4096
    s_add_u32 m0, m0, 4096
    s_nop 0
    buffer_load_dwordx4 v63, s[20:23], s47 offen offset:0 lds
    buffer_load_dwordx4 v[120:123], v3, s[20:23], s46 offen offset:2048
    buffer_load_dwordx4 v[124:127], v3, s[20:23], s46 offen offset:3072
    buffer_load_dwordx4 v[52:55], v11, s[20:23], s50 offen
    buffer_load_dwordx4 v[56:59], v11, s[20:23], s50 offen offset:16
    v_add_u32 v1, 0, v4
    v_and_b32 v1, 7, v1
    v_lshlrev_b32 v1, 4, v1
    v_xor_b32 v1, v1, v5
    v_add_u32 v1, v1, v6
    v_xor_b32 v60, 16, v1
    v_xor_b32 v61, 64, v1
    v_xor_b32 v62, 80, v1
    s_waitcnt vmcnt(30)
    ds_read_b128 v[240:243], v1 offset:0
    ds_read_b128 v[244:247], v60 offset:0
    ds_read_b128 v[248:251], v61 offset:0
    ds_read_b128 v[252:255], v62 offset:0
    s_waitcnt lgkmcnt(0)
    v_cvt_pk_bf16_f32 v12, v240, v241
    v_cvt_pk_bf16_f32 v13, v242, v243
    v_cvt_pk_bf16_f32 v14, v244, v245
    v_cvt_pk_bf16_f32 v15, v246, v247
    v_cvt_pk_bf16_f32 v16, v248, v249
    v_cvt_pk_bf16_f32 v17, v250, v251
    v_cvt_pk_bf16_f32 v18, v252, v253
    v_cvt_pk_bf16_f32 v19, v254, v255
    s_nop 1
    v_mfma_f32_32x32x16_bf16 v[20:35], v[12:15], v[64:67], 0
    v_mfma_f32_32x32x16_bf16 v[20:35], v[16:19], v[68:71], v[20:35]
    buffer_load_dwordx4 v[128:131], v3, s[20:23], s48 offen offset:0
    buffer_load_dwordx4 v[132:135], v3, s[20:23], s48 offen offset:1024
    buffer_load_dwordx4 v[136:139], v3, s[20:23], s48 offen offset:2048
    buffer_load_dwordx4 v[140:143], v3, s[20:23], s48 offen offset:3072
    v_add_u32 v1, 1, v4
    v_and_b32 v1, 7, v1
    v_lshlrev_b32 v1, 4, v1
    v_xor_b32 v1, v1, v5
    v_add_u32 v1, v1, v6
    v_xor_b32 v60, 16, v1
    v_xor_b32 v61, 64, v1
    v_xor_b32 v62, 80, v1
    s_waitcnt vmcnt(30)
    ds_read_b128 v[240:243], v1 offset:2176
    ds_read_b128 v[244:247], v60 offset:2176
    ds_read_b128 v[248:251], v61 offset:2176
    ds_read_b128 v[252:255], v62 offset:2176
    s_nop 3
    s_waitcnt lgkmcnt(0)
    v_cvt_pk_bf16_f32 v12, v240, v241
    v_cvt_pk_bf16_f32 v13, v242, v243
    v_cvt_pk_bf16_f32 v14, v244, v245
    v_cvt_pk_bf16_f32 v15, v246, v247
    v_cvt_pk_bf16_f32 v16, v248, v249
    v_cvt_pk_bf16_f32 v17, v250, v251
    v_cvt_pk_bf16_f32 v18, v252, v253
    v_cvt_pk_bf16_f32 v19, v254, v255
    s_nop 1
    v_mfma_f32_32x32x16_bf16 v[36:51], v[12:15], v[72:75], 0
    v_mfma_f32_32x32x16_bf16 v[36:51], v[16:19], v[76:79], v[36:51]
    s_add_u32 s48, s48, 4096
    buffer_load_dwordx4 v[144:147], v3, s[20:23], s48 offen offset:0
    buffer_load_dwordx4 v[148:151], v3, s[20:23], s48 offen offset:1024
    buffer_load_dwordx4 v[152:155], v3, s[20:23], s48 offen offset:2048
    buffer_load_dwordx4 v[156:159], v3, s[20:23], s48 offen offset:3072
    v_add_u32 v1, 2, v4
    v_and_b32 v1, 7, v1
    v_lshlrev_b32 v1, 4, v1
    v_xor_b32 v1, v1, v5
    v_add_u32 v1, v1, v6
    v_xor_b32 v60, 16, v1
    v_xor_b32 v61, 64, v1
    v_xor_b32 v62, 80, v1
    s_waitcnt vmcnt(30)
    ds_read_b128 v[240:243], v1 offset:4352
    ds_read_b128 v[244:247], v60 offset:4352
    ds_read_b128 v[248:251], v61 offset:4352
    ds_read_b128 v[252:255], v62 offset:4352
    v_add_f32 v11, 0x358637bd, v28
    v_rcp_f32 v11, v11
    s_nop 0
    v_mul_f32 v20, v20, v11
    v_mul_f32 v21, v21, v11
    v_mul_f32 v22, v22, v11
    v_mul_f32 v23, v23, v11
    v_mul_f32 v24, v24, v11
    v_mul_f32 v25, v25, v11
    v_mul_f32 v26, v26, v11
    v_mul_f32 v27, v27, v11
    v_cvt_pk_bf16_f32 v28, v20, v21
    v_cvt_pk_bf16_f32 v29, v22, v23
    v_cvt_pk_bf16_f32 v30, v24, v25
    v_cvt_pk_bf16_f32 v31, v26, v27
    ds_write_b128 v10, v[28:31] offset:0
    s_waitcnt lgkmcnt(1)
    v_cvt_pk_bf16_f32 v12, v240, v241
    v_cvt_pk_bf16_f32 v13, v242, v243
    v_cvt_pk_bf16_f32 v14, v244, v245
    v_cvt_pk_bf16_f32 v15, v246, v247
    v_cvt_pk_bf16_f32 v16, v248, v249
    v_cvt_pk_bf16_f32 v17, v250, v251
    v_cvt_pk_bf16_f32 v18, v252, v253
    v_cvt_pk_bf16_f32 v19, v254, v255
    s_nop 1
    v_mfma_f32_32x32x16_bf16 v[20:35], v[12:15], v[80:83], 0
    v_mfma_f32_32x32x16_bf16 v[20:35], v[16:19], v[84:87], v[20:35]
    s_add_u32 s48, s48, 4096
    buffer_load_dwordx4 v[160:163], v3, s[20:23], s48 offen offset:0
    buffer_load_dwordx4 v[164:167], v3, s[20:23], s48 offen offset:1024
    buffer_load_dwordx4 v[168:171], v3, s[20:23], s48 offen offset:2048
    buffer_load_dwordx4 v[172:175], v3, s[20:23], s48 offen offset:3072
    v_add_u32 v1, 3, v4
    v_and_b32 v1, 7, v1
    v_lshlrev_b32 v1, 4, v1
    v_xor_b32 v1, v1, v5
    v_add_u32 v1, v1, v6
    v_xor_b32 v60, 16, v1
    v_xor_b32 v61, 64, v1
    v_xor_b32 v62, 80, v1
    s_waitcnt vmcnt(30)
    ds_read_b128 v[240:243], v1 offset:6528
    ds_read_b128 v[244:247], v60 offset:6528
    ds_read_b128 v[248:251], v61 offset:6528
    ds_read_b128 v[252:255], v62 offset:6528
    v_add_f32 v11, 0x358637bd, v44
    v_rcp_f32 v11, v11
    s_nop 0
    v_mul_f32 v36, v36, v11
    v_mul_f32 v37, v37, v11
    v_mul_f32 v38, v38, v11
    v_mul_f32 v39, v39, v11
    v_mul_f32 v40, v40, v11
    v_mul_f32 v41, v41, v11
    v_mul_f32 v42, v42, v11
    v_mul_f32 v43, v43, v11
    v_cvt_pk_bf16_f32 v44, v36, v37
    v_cvt_pk_bf16_f32 v45, v38, v39
    v_cvt_pk_bf16_f32 v46, v40, v41
    v_cvt_pk_bf16_f32 v47, v42, v43
    ds_write_b128 v10, v[44:47] offset:1024
    s_waitcnt lgkmcnt(1)
    v_cvt_pk_bf16_f32 v12, v240, v241
    v_cvt_pk_bf16_f32 v13, v242, v243
    v_cvt_pk_bf16_f32 v14, v244, v245
    v_cvt_pk_bf16_f32 v15, v246, v247
    v_cvt_pk_bf16_f32 v16, v248, v249
    v_cvt_pk_bf16_f32 v17, v250, v251
    v_cvt_pk_bf16_f32 v18, v252, v253
    v_cvt_pk_bf16_f32 v19, v254, v255
    s_nop 1
    v_mfma_f32_32x32x16_bf16 v[36:51], v[12:15], v[88:91], 0
    v_mfma_f32_32x32x16_bf16 v[36:51], v[16:19], v[92:95], v[36:51]
    s_add_u32 s48, s48, 4096
    buffer_load_dwordx4 v[176:179], v3, s[20:23], s48 offen offset:0
    buffer_load_dwordx4 v[180:183], v3, s[20:23], s48 offen offset:1024
    buffer_load_dwordx4 v[184:187], v3, s[20:23], s48 offen offset:2048
    buffer_load_dwordx4 v[188:191], v3, s[20:23], s48 offen offset:3072
    v_add_u32 v1, 4, v4
    v_and_b32 v1, 7, v1
    v_lshlrev_b32 v1, 4, v1
    v_xor_b32 v1, v1, v5
    v_add_u32 v1, v1, v6
    v_xor_b32 v60, 16, v1
    v_xor_b32 v61, 64, v1
    v_xor_b32 v62, 80, v1
    s_waitcnt vmcnt(30)
    ds_read_b128 v[240:243], v1 offset:8704
    ds_read_b128 v[244:247], v60 offset:8704
    ds_read_b128 v[248:251], v61 offset:8704
    ds_read_b128 v[252:255], v62 offset:8704
    v_add_f32 v11, 0x358637bd, v28
    v_rcp_f32 v11, v11
    s_nop 0
    v_mul_f32 v20, v20, v11
    v_mul_f32 v21, v21, v11
    v_mul_f32 v22, v22, v11
    v_mul_f32 v23, v23, v11
    v_mul_f32 v24, v24, v11
    v_mul_f32 v25, v25, v11
    v_mul_f32 v26, v26, v11
    v_mul_f32 v27, v27, v11
    v_cvt_pk_bf16_f32 v28, v20, v21
    v_cvt_pk_bf16_f32 v29, v22, v23
    v_cvt_pk_bf16_f32 v30, v24, v25
    v_cvt_pk_bf16_f32 v31, v26, v27
    ds_write_b128 v10, v[28:31] offset:2048
    s_waitcnt lgkmcnt(1)
    v_cvt_pk_bf16_f32 v12, v240, v241
    v_cvt_pk_bf16_f32 v13, v242, v243
    v_cvt_pk_bf16_f32 v14, v244, v245
    v_cvt_pk_bf16_f32 v15, v246, v247
    v_cvt_pk_bf16_f32 v16, v248, v249
    v_cvt_pk_bf16_f32 v17, v250, v251
    v_cvt_pk_bf16_f32 v18, v252, v253
    v_cvt_pk_bf16_f32 v19, v254, v255
    s_nop 1
    v_mfma_f32_32x32x16_bf16 v[20:35], v[12:15], v[96:99], 0
    v_mfma_f32_32x32x16_bf16 v[20:35], v[16:19], v[100:103], v[20:35]
    s_add_u32 s48, s48, 4096
    buffer_load_dwordx4 v[192:195], v3, s[20:23], s48 offen offset:0
    buffer_load_dwordx4 v[196:199], v3, s[20:23], s48 offen offset:1024
    buffer_load_dwordx4 v[200:203], v3, s[20:23], s48 offen offset:2048
    buffer_load_dwordx4 v[204:207], v3, s[20:23], s48 offen offset:3072
    v_add_u32 v1, 5, v4
    v_and_b32 v1, 7, v1
    v_lshlrev_b32 v1, 4, v1
    v_xor_b32 v1, v1, v5
    v_add_u32 v1, v1, v6
    v_xor_b32 v60, 16, v1
    v_xor_b32 v61, 64, v1
    v_xor_b32 v62, 80, v1
    s_waitcnt vmcnt(30)
    ds_read_b128 v[240:243], v1 offset:10880
    ds_read_b128 v[244:247], v60 offset:10880
    ds_read_b128 v[248:251], v61 offset:10880
    ds_read_b128 v[252:255], v62 offset:10880
    v_add_f32 v11, 0x358637bd, v44
    v_rcp_f32 v11, v11
    s_nop 0
    v_mul_f32 v36, v36, v11
    v_mul_f32 v37, v37, v11
    v_mul_f32 v38, v38, v11
    v_mul_f32 v39, v39, v11
    v_mul_f32 v40, v40, v11
    v_mul_f32 v41, v41, v11
    v_mul_f32 v42, v42, v11
    v_mul_f32 v43, v43, v11
    v_cvt_pk_bf16_f32 v44, v36, v37
    v_cvt_pk_bf16_f32 v45, v38, v39
    v_cvt_pk_bf16_f32 v46, v40, v41
    v_cvt_pk_bf16_f32 v47, v42, v43
    ds_write_b128 v10, v[44:47] offset:3072
    s_waitcnt lgkmcnt(1)
    v_cvt_pk_bf16_f32 v12, v240, v241
    v_cvt_pk_bf16_f32 v13, v242, v243
    v_cvt_pk_bf16_f32 v14, v244, v245
    v_cvt_pk_bf16_f32 v15, v246, v247
    v_cvt_pk_bf16_f32 v16, v248, v249
    v_cvt_pk_bf16_f32 v17, v250, v251
    v_cvt_pk_bf16_f32 v18, v252, v253
    v_cvt_pk_bf16_f32 v19, v254, v255
    s_nop 1
    v_mfma_f32_32x32x16_bf16 v[36:51], v[12:15], v[104:107], 0
    v_mfma_f32_32x32x16_bf16 v[36:51], v[16:19], v[108:111], v[36:51]
    s_add_u32 s48, s48, 4096
    buffer_load_dwordx4 v[208:211], v3, s[20:23], s48 offen offset:0
    buffer_load_dwordx4 v[212:215], v3, s[20:23], s48 offen offset:1024
    buffer_load_dwordx4 v[216:219], v3, s[20:23], s48 offen offset:2048
    buffer_load_dwordx4 v[220:223], v3, s[20:23], s48 offen offset:3072
    v_add_u32 v1, 6, v4
    v_and_b32 v1, 7, v1
    v_lshlrev_b32 v1, 4, v1
    v_xor_b32 v1, v1, v5
    v_add_u32 v1, v1, v6
    v_xor_b32 v60, 16, v1
    v_xor_b32 v61, 64, v1
    v_xor_b32 v62, 80, v1
    s_waitcnt vmcnt(30)
    ds_read_b128 v[240:243], v1 offset:13056
    ds_read_b128 v[244:247], v60 offset:13056
    ds_read_b128 v[248:251], v61 offset:13056
    ds_read_b128 v[252:255], v62 offset:13056
    v_add_f32 v11, 0x358637bd, v28
    v_rcp_f32 v11, v11
    s_nop 0
    v_mul_f32 v20, v20, v11
    v_mul_f32 v21, v21, v11
    v_mul_f32 v22, v22, v11
    v_mul_f32 v23, v23, v11
    v_mul_f32 v24, v24, v11
    v_mul_f32 v25, v25, v11
    v_mul_f32 v26, v26, v11
    v_mul_f32 v27, v27, v11
    v_cvt_pk_bf16_f32 v28, v20, v21
    v_cvt_pk_bf16_f32 v29, v22, v23
    v_cvt_pk_bf16_f32 v30, v24, v25
    v_cvt_pk_bf16_f32 v31, v26, v27
    ds_write_b128 v10, v[28:31] offset:4096
    s_waitcnt lgkmcnt(1)
    v_cvt_pk_bf16_f32 v12, v240, v241
    v_cvt_pk_bf16_f32 v13, v242, v243
    v_cvt_pk_bf16_f32 v14, v244, v245
    v_cvt_pk_bf16_f32 v15, v246, v247
    v_cvt_pk_bf16_f32 v16, v248, v249
    v_cvt_pk_bf16_f32 v17, v250, v251
    v_cvt_pk_bf16_f32 v18, v252, v253
    v_cvt_pk_bf16_f32 v19, v254, v255
    s_nop 1
    v_mfma_f32_32x32x16_bf16 v[20:35], v[12:15], v[112:115], 0
    v_mfma_f32_32x32x16_bf16 v[20:35], v[16:19], v[116:119], v[20:35]
    s_add_u32 s48, s48, 4096
    buffer_load_dwordx4 v[224:227], v3, s[20:23], s48 offen offset:0
    buffer_load_dwordx4 v[228:231], v3, s[20:23], s48 offen offset:1024
    buffer_load_dwordx4 v[232:235], v3, s[20:23], s48 offen offset:2048
    buffer_load_dwordx4 v[236:239], v3, s[20:23], s48 offen offset:3072
    v_add_u32 v1, 7, v4
    v_and_b32 v1, 7, v1
    v_lshlrev_b32 v1, 4, v1
    v_xor_b32 v1, v1, v5
    v_add_u32 v1, v1, v6
    v_xor_b32 v60, 16, v1
    v_xor_b32 v61, 64, v1
    v_xor_b32 v62, 80, v1
    s_waitcnt vmcnt(30)
    ds_read_b128 v[240:243], v1 offset:15232
    ds_read_b128 v[244:247], v60 offset:15232
    ds_read_b128 v[248:251], v61 offset:15232
    ds_read_b128 v[252:255], v62 offset:15232
    v_add_f32 v11, 0x358637bd, v44
    v_rcp_f32 v11, v11
    s_nop 0
    v_mul_f32 v36, v36, v11
    v_mul_f32 v37, v37, v11
    v_mul_f32 v38, v38, v11
    v_mul_f32 v39, v39, v11
    v_mul_f32 v40, v40, v11
    v_mul_f32 v41, v41, v11
    v_mul_f32 v42, v42, v11
    v_mul_f32 v43, v43, v11
    v_cvt_pk_bf16_f32 v44, v36, v37
    v_cvt_pk_bf16_f32 v45, v38, v39
    v_cvt_pk_bf16_f32 v46, v40, v41
    v_cvt_pk_bf16_f32 v47, v42, v43
    ds_write_b128 v10, v[44:47] offset:5120
    s_waitcnt lgkmcnt(1)
    v_cvt_pk_bf16_f32 v12, v240, v241
    v_cvt_pk_bf16_f32 v13, v242, v243
    v_cvt_pk_bf16_f32 v14, v244, v245
    v_cvt_pk_bf16_f32 v15, v246, v247
    v_cvt_pk_bf16_f32 v16, v248, v249
    v_cvt_pk_bf16_f32 v17, v250, v251
    v_cvt_pk_bf16_f32 v18, v252, v253
    v_cvt_pk_bf16_f32 v19, v254, v255
    s_nop 1
    v_mfma_f32_32x32x16_bf16 v[36:51], v[12:15], v[120:123], 0
    v_mfma_f32_32x32x16_bf16 v[36:51], v[16:19], v[124:127], v[36:51]
    s_add_u32 s48, s48, 4096
    buffer_load_dwordx4 v[240:243], v3, s[20:23], s48 offen offset:0
    buffer_load_dwordx4 v[244:247], v3, s[20:23], s48 offen offset:1024
    buffer_load_dwordx4 v[248:251], v3, s[20:23], s48 offen offset:2048
    buffer_load_dwordx4 v[252:255], v3, s[20:23], s48 offen offset:3072
    v_lshrrev_b32 v4, 2, v0
    v_and_b32 v5, 3, v0
    v_lshlrev_b32 v4, 8, v4
    v_lshl_add_u32 v4, v5, 4, v4
    v_add_u32 v5, 0x4000, v4
    s_lshl_b32 s52, s45, 15
    s_lshr_b32 s53, s44, 2
    s_lshl_b32 s53, s53, 17
    s_add_u32 s52, s52, s53
    s_and_b32 s53, s44, 3
    s_lshl_b32 s53, s53, 6
    s_add_u32 s52, s52, s53
    s_add_u32 s53, s52, 9437184
    buffer_load_dwordx4 v[88:91], v4, s[20:23], s53 offen
    buffer_load_dwordx4 v[92:95], v5, s[20:23], s53 offen
    v_add_f32 v11, 0x358637bd, v28
    v_rcp_f32 v11, v11
    s_nop 0
    v_mul_f32 v20, v20, v11
    v_mul_f32 v21, v21, v11
    v_mul_f32 v22, v22, v11
    v_mul_f32 v23, v23, v11
    v_mul_f32 v24, v24, v11
    v_mul_f32 v25, v25, v11
    v_mul_f32 v26, v26, v11
    v_mul_f32 v27, v27, v11
    v_cvt_pk_bf16_f32 v28, v20, v21
    v_cvt_pk_bf16_f32 v29, v22, v23
    v_cvt_pk_bf16_f32 v30, v24, v25
    v_cvt_pk_bf16_f32 v31, v26, v27
    ds_write_b128 v10, v[28:31] offset:6144
    s_nop 7
    v_add_f32 v11, 0x358637bd, v44
    v_rcp_f32 v11, v11
    s_nop 0
    v_mul_f32 v36, v36, v11
    v_mul_f32 v37, v37, v11
    v_mul_f32 v38, v38, v11
    v_mul_f32 v39, v39, v11
    v_mul_f32 v40, v40, v11
    v_mul_f32 v41, v41, v11
    v_mul_f32 v42, v42, v11
    v_mul_f32 v43, v43, v11
    v_cvt_pk_bf16_f32 v44, v36, v37
    v_cvt_pk_bf16_f32 v45, v38, v39
    v_cvt_pk_bf16_f32 v46, v40, v41
    v_cvt_pk_bf16_f32 v47, v42, v43
    ds_write_b128 v10, v[44:47] offset:7168
    s_waitcnt lgkmcnt(0)
    s_barrier
    ds_read_b128 v[64:67], v3 offset:0
    ds_read_b128 v[68:71], v3 offset:1024
    ds_read_b128 v[72:75], v3 offset:2048
    ds_read_b128 v[76:79], v3 offset:3072
    s_waitcnt vmcnt(33)
    s_waitcnt lgkmcnt(3)
    v_mfma_f32_32x32x16_bf16 v[20:35], v[128:131], v[64:67], 0
    ds_read_b128 v[80:83], v3 offset:4096
    s_waitcnt vmcnt(32)
    s_waitcnt lgkmcnt(3)
    v_mfma_f32_32x32x16_bf16 v[20:35], v[132:135], v[68:71], v[20:35]
    ds_read_b128 v[84:87], v3 offset:5120
    s_waitcnt vmcnt(31)
    s_waitcnt lgkmcnt(3)
    v_mfma_f32_32x32x16_bf16 v[20:35], v[136:139], v[72:75], v[20:35]
    ds_read_b128 v[64:67], v3 offset:6144
    s_waitcnt vmcnt(30)
    s_waitcnt lgkmcnt(3)
    v_mfma_f32_32x32x16_bf16 v[20:35], v[140:143], v[76:79], v[20:35]
    ds_read_b128 v[68:71], v3 offset:7168
    s_waitcnt vmcnt(29)
    s_waitcnt lgkmcnt(3)
    v_mfma_f32_32x32x16_bf16 v[20:35], v[144:147], v[80:83], v[20:35]
    ds_read_b128 v[72:75], v3 offset:8192
    s_waitcnt vmcnt(28)
    s_waitcnt lgkmcnt(3)
    v_mfma_f32_32x32x16_bf16 v[20:35], v[148:151], v[84:87], v[20:35]
    ds_read_b128 v[76:79], v3 offset:9216
    s_waitcnt vmcnt(27)
    s_waitcnt lgkmcnt(3)
    v_mfma_f32_32x32x16_bf16 v[20:35], v[152:155], v[64:67], v[20:35]
    ds_read_b128 v[80:83], v3 offset:10240
    s_waitcnt vmcnt(26)
    s_waitcnt lgkmcnt(3)
    v_mfma_f32_32x32x16_bf16 v[20:35], v[156:159], v[68:71], v[20:35]
    ds_read_b128 v[84:87], v3 offset:11264
    s_waitcnt vmcnt(25)
    s_waitcnt lgkmcnt(3)
    v_mfma_f32_32x32x16_bf16 v[20:35], v[160:163], v[72:75], v[20:35]
    ds_read_b128 v[64:67], v3 offset:12288
    s_waitcnt vmcnt(24)
    s_waitcnt lgkmcnt(3)
    v_mfma_f32_32x32x16_bf16 v[20:35], v[164:167], v[76:79], v[20:35]
    ds_read_b128 v[68:71], v3 offset:13312
    s_waitcnt vmcnt(23)
    s_waitcnt lgkmcnt(3)
    v_mfma_f32_32x32x16_bf16 v[20:35], v[168:171], v[80:83], v[20:35]
    ds_read_b128 v[72:75], v3 offset:14336
    s_waitcnt vmcnt(22)
    s_waitcnt lgkmcnt(3)
    v_mfma_f32_32x32x16_bf16 v[20:35], v[172:175], v[84:87], v[20:35]
    ds_read_b128 v[76:79], v3 offset:15360
    s_waitcnt vmcnt(21)
    s_waitcnt lgkmcnt(3)
    v_mfma_f32_32x32x16_bf16 v[20:35], v[176:179], v[64:67], v[20:35]
    ds_read_b128 v[80:83], v3 offset:16384
    s_waitcnt vmcnt(20)
    s_waitcnt lgkmcnt(3)
    v_mfma_f32_32x32x16_bf16 v[20:35], v[180:183], v[68:71], v[20:35]
    ds_read_b128 v[84:87], v3 offset:17408
    s_waitcnt vmcnt(19)
    s_waitcnt lgkmcnt(3)
    v_mfma_f32_32x32x16_bf16 v[20:35], v[184:187], v[72:75], v[20:35]
    ds_read_b128 v[64:67], v3 offset:18432
    s_waitcnt vmcnt(18)
    s_waitcnt lgkmcnt(3)
    v_mfma_f32_32x32x16_bf16 v[20:35], v[188:191], v[76:79], v[20:35]
    ds_read_b128 v[68:71], v3 offset:19456
    s_waitcnt vmcnt(17)
    s_waitcnt lgkmcnt(3)
    v_mfma_f32_32x32x16_bf16 v[20:35], v[192:195], v[80:83], v[20:35]
    ds_read_b128 v[72:75], v3 offset:20480
    s_waitcnt vmcnt(16)
    s_waitcnt lgkmcnt(3)
    v_mfma_f32_32x32x16_bf16 v[20:35], v[196:199], v[84:87], v[20:35]
    ds_read_b128 v[76:79], v3 offset:21504
    s_waitcnt vmcnt(15)
    s_waitcnt lgkmcnt(3)
    v_mfma_f32_32x32x16_bf16 v[20:35], v[200:203], v[64:67], v[20:35]
    ds_read_b128 v[80:83], v3 offset:22528
    s_waitcnt vmcnt(14)
    s_waitcnt lgkmcnt(3)
    v_mfma_f32_32x32x16_bf16 v[20:35], v[204:207], v[68:71], v[20:35]
    ds_read_b128 v[84:87], v3 offset:23552
    s_waitcnt vmcnt(13)
    s_waitcnt lgkmcnt(3)
    v_mfma_f32_32x32x16_bf16 v[20:35], v[208:211], v[72:75], v[20:35]
    ds_read_b128 v[64:67], v3 offset:24576
    s_waitcnt vmcnt(12)
    s_waitcnt lgkmcnt(3)
    v_mfma_f32_32x32x16_bf16 v[20:35], v[212:215], v[76:79], v[20:35]
    ds_read_b128 v[68:71], v3 offset:25600
    s_waitcnt vmcnt(11)
    s_waitcnt lgkmcnt(3)
    v_mfma_f32_32x32x16_bf16 v[20:35], v[216:219], v[80:83], v[20:35]
    ds_read_b128 v[72:75], v3 offset:26624
    s_waitcnt vmcnt(10)
    s_waitcnt lgkmcnt(3)
    v_mfma_f32_32x32x16_bf16 v[20:35], v[220:223], v[84:87], v[20:35]
    ds_read_b128 v[76:79], v3 offset:27648
    s_waitcnt vmcnt(9)
    s_waitcnt lgkmcnt(3)
    v_mfma_f32_32x32x16_bf16 v[20:35], v[224:227], v[64:67], v[20:35]
    ds_read_b128 v[80:83], v3 offset:28672
    s_waitcnt vmcnt(8)
    s_waitcnt lgkmcnt(3)
    v_mfma_f32_32x32x16_bf16 v[20:35], v[228:231], v[68:71], v[20:35]
    ds_read_b128 v[84:87], v3 offset:29696
    s_waitcnt vmcnt(7)
    s_waitcnt lgkmcnt(3)
    v_mfma_f32_32x32x16_bf16 v[20:35], v[232:235], v[72:75], v[20:35]
    ds_read_b128 v[64:67], v3 offset:30720
    s_waitcnt vmcnt(6)
    s_waitcnt lgkmcnt(3)
    v_mfma_f32_32x32x16_bf16 v[20:35], v[236:239], v[76:79], v[20:35]
    ds_read_b128 v[68:71], v3 offset:31744
    s_waitcnt vmcnt(5)
    s_waitcnt lgkmcnt(3)
    v_mfma_f32_32x32x16_bf16 v[20:35], v[240:243], v[80:83], v[20:35]
    s_waitcnt vmcnt(4)
    s_waitcnt lgkmcnt(2)
    v_mfma_f32_32x32x16_bf16 v[20:35], v[244:247], v[84:87], v[20:35]
    s_waitcnt vmcnt(3)
    s_waitcnt lgkmcnt(1)
    v_mfma_f32_32x32x16_bf16 v[20:35], v[248:251], v[64:67], v[20:35]
    s_waitcnt vmcnt(2)
    s_waitcnt lgkmcnt(0)
    v_mfma_f32_32x32x16_bf16 v[20:35], v[252:255], v[68:71], v[20:35]
    s_mov_b32 s54, 0xffff0000
    v_lshlrev_b32 v64, 16, v52
    v_and_b32 v65, s54, v52
    v_lshlrev_b32 v66, 16, v53
    v_and_b32 v67, s54, v53
    v_lshlrev_b32 v68, 16, v54
    v_and_b32 v69, s54, v54
    v_lshlrev_b32 v70, 16, v55
    v_and_b32 v71, s54, v55
    v_lshlrev_b32 v72, 16, v56
    v_and_b32 v73, s54, v56
    v_lshlrev_b32 v74, 16, v57
    v_and_b32 v75, s54, v57
    v_lshlrev_b32 v76, 16, v58
    v_and_b32 v77, s54, v58
    v_lshlrev_b32 v78, 16, v59
    v_and_b32 v79, s54, v59
    v_add_f32 v64, v64, v20
    v_add_f32 v65, v65, v21
    v_add_f32 v66, v66, v22
    v_add_f32 v67, v67, v23
    v_add_f32 v68, v68, v24
    v_add_f32 v69, v69, v25
    v_add_f32 v70, v70, v26
    v_add_f32 v71, v71, v27
    v_add_f32 v72, v72, v28
    v_add_f32 v73, v73, v29
    v_add_f32 v74, v74, v30
    v_add_f32 v75, v75, v31
    v_add_f32 v76, v76, v32
    v_add_f32 v77, v77, v33
    v_add_f32 v78, v78, v34
    v_add_f32 v79, v79, v35
    v_cvt_pk_bf16_f32 v80, v64, v65
    v_cvt_pk_bf16_f32 v81, v66, v67
    v_cvt_pk_bf16_f32 v82, v68, v69
    v_cvt_pk_bf16_f32 v83, v70, v71
    v_cvt_pk_bf16_f32 v84, v72, v73
    v_cvt_pk_bf16_f32 v85, v74, v75
    v_cvt_pk_bf16_f32 v86, v76, v77
    v_cvt_pk_bf16_f32 v87, v78, v79
    v_mov_b32 v12, 0
    v_mov_b32 v13, 0
    v_mov_b32 v14, 0x3f803f80
    v_dot2_f32_bf16 v12, v80, v14, v12
    v_dot2_f32_bf16 v13, v80, v80, v13
    v_dot2_f32_bf16 v12, v81, v14, v12
    v_dot2_f32_bf16 v13, v81, v81, v13
    v_dot2_f32_bf16 v12, v82, v14, v12
    v_dot2_f32_bf16 v13, v82, v82, v13
    v_dot2_f32_bf16 v12, v83, v14, v12
    v_dot2_f32_bf16 v13, v83, v83, v13
    v_dot2_f32_bf16 v12, v84, v14, v12
    v_dot2_f32_bf16 v13, v84, v84, v13
    v_dot2_f32_bf16 v12, v85, v14, v12
    v_dot2_f32_bf16 v13, v85, v85, v13
    v_dot2_f32_bf16 v12, v86, v14, v12
    v_dot2_f32_bf16 v13, v86, v86, v13
    v_dot2_f32_bf16 v12, v87, v14, v12
    v_dot2_f32_bf16 v13, v87, v87, v13
    s_lshl_b32 s55, s41, 11
    s_add_u32 s55, s55, 32768
    v_lshlrev_b32 v15, 1, v8
    v_lshl_add_u32 v15, v7, 10, v15
    v_add_u32 v15, s55, v15
    v_mov_b32 v16, v12
    v_mov_b32 v17, v13
    s_lshl_b32 s55, s41, 8
    s_add_u32 s55, s55, 40960
    v_permlane32_swap_b32 v16, v12
    v_permlane32_swap_b32 v17, v13
    v_lshlrev_b32 v18, 3, v8
    v_add_u32 v19, s55, v18
    v_add_f32 v12, v12, v16
    v_add_f32 v13, v13, v17
    ds_write_b64 v19, v[12:13]
    ds_write_b16 v15, v80 offset:0
    ds_write_b16_d16_hi v15, v80 offset:64
    ds_write_b16 v15, v81 offset:128
    ds_write_b16_d16_hi v15, v81 offset:192
    ds_write_b16 v15, v82 offset:256
    ds_write_b16_d16_hi v15, v82 offset:320
    ds_write_b16 v15, v83 offset:384
    ds_write_b16_d16_hi v15, v83 offset:448
    ds_write_b16 v15, v84 offset:512
    ds_write_b16_d16_hi v15, v84 offset:576
    ds_write_b16 v15, v85 offset:640
    ds_write_b16_d16_hi v15, v85 offset:704
    ds_write_b16 v15, v86 offset:768
    ds_write_b16_d16_hi v15, v86 offset:832
    ds_write_b16 v15, v87 offset:896
    ds_write_b16_d16_hi v15, v87 offset:960
    v_lshlrev_b32 v20, 4, v0
    v_and_b32 v21, 3, v0
    v_lshlrev_b32 v21, 5, v21
    s_waitcnt lgkmcnt(0)
    s_barrier
    ds_read_b128 v[24:27], v20 offset:32768
    ds_read_b128 v[28:31], v20 offset:36864
    s_cmp_lg_u32 s41, 0
    s_cbranch_scc1 K4_W
    ds_read_b64 v[32:33], v18 offset:40960
    ds_read_b64 v[34:35], v18 offset:41216
    ds_read_b64 v[36:37], v18 offset:41472
    ds_read_b64 v[38:39], v18 offset:41728
    s_lshl_b32 s55, s44, 10
    s_add_u32 s55, s55, 26214400
    s_lshl_b32 s56, s45, 8
    s_add_u32 s56, s56, s55
    v_lshl_add_u32 v19, v7, 8, v18
    s_mov_b32 s57, 0x40000
    s_waitcnt lgkmcnt(0)
    v_pk_add_f32 v[32:33], v[32:33], v[34:35]
    v_pk_add_f32 v[36:37], v[36:37], v[38:39]
    v_pk_add_f32 v[32:33], v[32:33], v[36:37]
    s_mov_b32 exec_hi, 0
    buffer_store_dwordx2 v[32:33], v18, s[20:23], s56 offen sc0 sc1
    s_mov_b32 exec_hi, -1
K4_POLL:
    buffer_load_dwordx2 v[34:35], v19, s[20:23], s55 offen sc0 sc1
    buffer_load_dwordx2 v[36:37], v19, s[20:23], s55 offen offset:512 sc0 sc1
    s_sub_u32 s57, s57, 1
    s_cmp_eq_u32 s57, 0
    s_cbranch_scc1 K4_GO
    s_waitcnt vmcnt(0)
    v_cmp_eq_u32 vcc, -1, v34
    v_cmp_eq_u32 s[58:59], -1, v35
    v_cmp_eq_u32 s[60:61], -1, v36
    v_cmp_eq_u32 s[62:63], -1, v37
    s_or_b64 s[58:59], s[58:59], vcc
    s_or_b64 s[60:61], s[60:61], s[62:63]
    s_or_b64 s[58:59], s[58:59], s[60:61]
    s_cbranch_scc1 K4_POLL
K4_GO:
    s_waitcnt vmcnt(0)
    v_pk_add_f32 v[34:35], v[34:35], v[36:37]
    s_nop 0
    v_mov_b32 v36, v34
    v_mov_b32 v37, v35
    s_nop 1
    v_permlane32_swap_b32 v36, v34
    v_permlane32_swap_b32 v37, v35
    s_nop 1
    v_add_f32 v34, v34, v36
    v_add_f32 v35, v35, v37
    v_mul_f32 v34, 0x3b000000, v34
    v_mul_f32 v35, 0x3b000000, v35
    v_fma_f32 v35, -v34, v34, v35
    v_max_f32 v35, 0, v35
    v_add_f32 v35, 0x3727c5ac, v35
    v_rsq_f32 v35, v35
    v_lshlrev_b32 v36, 2, v8
    v_mul_f32 v34, v34, v35
    ds_write_b32 v36, v35 offset:41984
    ds_write_b32 v36, v34 offset:42112
    s_waitcnt lgkmcnt(0)
K4_W:
    s_barrier
    ds_read_b128 v[32:35], v21 offset:41984
    ds_read_b128 v[36:39], v21 offset:42000
    ds_read_b128 v[40:43], v21 offset:42112
    ds_read_b128 v[44:47], v21 offset:42128
    s_add_u32 s53, s52, 13631488
    s_waitcnt vmcnt(0) lgkmcnt(0)
    v_lshlrev_b32 v48, 16, v24
    v_and_b32 v49, s54, v24
    v_lshlrev_b32 v50, 16, v88
    v_and_b32 v51, s54, v88
    v_pk_fma_f32 v[52:53], v[48:49], v[32:33], v[40:41] neg_lo:[0,0,1] neg_hi:[0,0,1]
    v_pk_fma_f32 v[48:49], v[52:53], v[50:51], v[48:49]
    v_cvt_pk_bf16_f32 v64, v48, v49
    v_lshlrev_b32 v48, 16, v25
    v_and_b32 v49, s54, v25
    v_lshlrev_b32 v50, 16, v89
    v_and_b32 v51, s54, v89
    v_pk_fma_f32 v[52:53], v[48:49], v[34:35], v[42:43] neg_lo:[0,0,1] neg_hi:[0,0,1]
    v_pk_fma_f32 v[48:49], v[52:53], v[50:51], v[48:49]
    v_cvt_pk_bf16_f32 v65, v48, v49
    v_lshlrev_b32 v48, 16, v26
    v_and_b32 v49, s54, v26
    v_lshlrev_b32 v50, 16, v90
    v_and_b32 v51, s54, v90
    v_pk_fma_f32 v[52:53], v[48:49], v[36:37], v[44:45] neg_lo:[0,0,1] neg_hi:[0,0,1]
    v_pk_fma_f32 v[48:49], v[52:53], v[50:51], v[48:49]
    v_cvt_pk_bf16_f32 v66, v48, v49
    v_lshlrev_b32 v48, 16, v27
    v_and_b32 v49, s54, v27
    v_lshlrev_b32 v50, 16, v91
    v_and_b32 v51, s54, v91
    v_pk_fma_f32 v[52:53], v[48:49], v[38:39], v[46:47] neg_lo:[0,0,1] neg_hi:[0,0,1]
    v_pk_fma_f32 v[48:49], v[52:53], v[50:51], v[48:49]
    v_cvt_pk_bf16_f32 v67, v48, v49
    buffer_store_dwordx4 v[64:67], v4, s[20:23], s53 offen sc1
    v_lshlrev_b32 v48, 16, v28
    v_and_b32 v49, s54, v28
    v_lshlrev_b32 v50, 16, v92
    v_and_b32 v51, s54, v92
    v_pk_fma_f32 v[52:53], v[48:49], v[32:33], v[40:41] neg_lo:[0,0,1] neg_hi:[0,0,1]
    v_pk_fma_f32 v[48:49], v[52:53], v[50:51], v[48:49]
    v_cvt_pk_bf16_f32 v68, v48, v49
    v_lshlrev_b32 v48, 16, v29
    v_and_b32 v49, s54, v29
    v_lshlrev_b32 v50, 16, v93
    v_and_b32 v51, s54, v93
    v_pk_fma_f32 v[52:53], v[48:49], v[34:35], v[42:43] neg_lo:[0,0,1] neg_hi:[0,0,1]
    v_pk_fma_f32 v[48:49], v[52:53], v[50:51], v[48:49]
    v_cvt_pk_bf16_f32 v69, v48, v49
    v_lshlrev_b32 v48, 16, v30
    v_and_b32 v49, s54, v30
    v_lshlrev_b32 v50, 16, v94
    v_and_b32 v51, s54, v94
    v_pk_fma_f32 v[52:53], v[48:49], v[36:37], v[44:45] neg_lo:[0,0,1] neg_hi:[0,0,1]
    v_pk_fma_f32 v[48:49], v[52:53], v[50:51], v[48:49]
    v_cvt_pk_bf16_f32 v70, v48, v49
    v_lshlrev_b32 v48, 16, v31
    v_and_b32 v49, s54, v31
    v_lshlrev_b32 v50, 16, v95
    v_and_b32 v51, s54, v95
    v_pk_fma_f32 v[52:53], v[48:49], v[38:39], v[46:47] neg_lo:[0,0,1] neg_hi:[0,0,1]
    v_pk_fma_f32 v[48:49], v[52:53], v[50:51], v[48:49]
    v_cvt_pk_bf16_f32 v71, v48, v49
    buffer_store_dwordx4 v[68:71], v5, s[20:23], s53 offen sc1
K4_DONE:
    s_endpgm
.globl qkv2_kernel
.p2align 8
.type qkv2_kernel,@function
qkv2_kernel:
    s_cmp_ge_u32 s2, 256
    s_cbranch_scc1 K5_DONE
    s_load_dwordx2 s[18:19], s[0:1], 96
    s_load_dwordx2 s[16:17], s[0:1], 80
    v_lshrrev_b32 v1, 6, v0
    v_and_b32 v2, 63, v0
    v_readfirstlane_b32 s41, v1
    s_and_b32 s42, s2, 7
    s_lshr_b32 s43, s2, 3
    s_lshr_b32 s44, s42, 1
    s_lshl_b32 s44, s44, 2
    s_and_b32 s45, s43, 3
    s_add_u32 s44, s44, s45
    s_and_b32 s45, s42, 1
    s_lshl_b32 s45, s45, 3
    s_lshr_b32 s46, s43, 2
    s_add_u32 s45, s45, s46
    v_lshrrev_b32 v3, 4, v2
    v_and_b32 v4, 15, v2
    v_lshlrev_b32 v5, 2, v3
    v_xor_b32 v5, v5, v4
    v_lshlrev_b32 v5, 4, v5
    v_lshl_add_u32 v5, v3, 8, v5
    v_lshlrev_b32 v6, 4, v2
    v_lshrrev_b32 v7, 5, v2
    v_and_b32 v8, 31, v2
    s_lshl_b32 s47, s45, 5
    s_lshl_b32 s48, s41, 4
    s_add_u32 s47, s47, s48
    s_lshl_b32 s48, s44, 17
    s_add_u32 s48, s48, 13631488
    s_lshl_b32 s49, s45, 1
    s_add_u32 s49, s49, s41
    s_mul_i32 s50, s45, 98304
    s_add_u32 s50, s50, 5242880
    s_lshl_b32 s51, s41, 12
    s_mul_i32 s52, s41, 3072
    s_add_u32 s52, s52, 16384
    s_mul_i32 s53, s45, 384
    s_add_u32 s53, s53, 7340032
    v_lshlrev_b32 v9, 6, v7
    s_waitcnt lgkmcnt(0)
    s_mov_b32 s20, s18
    s_mov_b32 s21, s19
    s_mov_b32 s22, 33554432
    s_mov_b32 s23, 0x20000
    s_cmp_lt_u32 s41, 4
    s_cbranch_scc1 K5_C
    s_sub_u32 s41, s41, 4
    s_lshl_b32 s41, s41, 1
    s_lshl_b32 s47, s45, 5
    s_lshl_b32 s51, s41, 4
    s_add_u32 s47, s47, s51
    s_lshl_b32 s49, s45, 1
    s_add_u32 s49, s49, s41
    s_lshl_b32 s51, s41, 12
    s_mul_i32 s52, s41, 3072
    s_add_u32 s52, s52, 16384
    s_add_u32 s54, s47, 0
    s_and_b32 s54, s54, 511
    s_lshl_b32 s54, s54, 8
    s_add_u32 m0, s51, 0
    s_add_u32 s54, s54, s48
    buffer_load_dwordx4 v5, s[20:23], s54 offen offset:0 lds
    buffer_load_dwordx4 v5, s[20:23], s54 offen offset:1024 lds
    buffer_load_dwordx4 v5, s[20:23], s54 offen offset:2048 lds
    buffer_load_dwordx4 v5, s[20:23], s54 offen offset:3072 lds
    s_add_u32 s54, s49, 0
    s_and_b32 s54, s54, 31
    s_mul_i32 s54, s54, 3072
    s_add_u32 m0, s52, 0
    s_add_u32 s54, s54, s50
    buffer_load_dwordx4 v6, s[20:23], s54 offen offset:0 lds
    buffer_load_dwordx4 v6, s[20:23], s54 offen offset:1024 lds
    buffer_load_dwordx4 v6, s[20:23], s54 offen offset:2048 lds
    s_add_u32 s54, s47, 16
    s_and_b32 s54, s54, 511
    s_lshl_b32 s54, s54, 8
    s_add_u32 m0, s51, 4096
    s_add_u32 s54, s54, s48
    buffer_load_dwordx4 v5, s[20:23], s54 offen offset:0 lds
    buffer_load_dwordx4 v5, s[20:23], s54 offen offset:1024 lds
    buffer_load_dwordx4 v5, s[20:23], s54 offen offset:2048 lds
    buffer_load_dwordx4 v5, s[20:23], s54 offen offset:3072 lds
    s_add_u32 s54, s49, 1
    s_and_b32 s54, s54, 31
    s_mul_i32 s54, s54, 3072
    s_add_u32 m0, s52, 3072
    s_add_u32 s54, s54, s50
    buffer_load_dwordx4 v6, s[20:23], s54 offen offset:0 lds
    buffer_load_dwordx4 v6, s[20:23], s54 offen offset:1024 lds
    buffer_load_dwordx4 v6, s[20:23], s54 offen offset:2048 lds
    s_add_u32 s54, s47, 64
    s_and_b32 s54, s54, 511
    s_lshl_b32 s54, s54, 8
    s_add_u32 m0, s51, 28672
    s_add_u32 s54, s54, s48
    buffer_load_dwordx4 v5, s[20:23], s54 offen offset:0 lds
    buffer_load_dwordx4 v5, s[20:23], s54 offen offset:1024 lds
    buffer_load_dwordx4 v5, s[20:23], s54 offen offset:2048 lds
    buffer_load_dwordx4 v5, s[20:23], s54 offen offset:3072 lds
    s_add_u32 s54, s49, 4
    s_and_b32 s54, s54, 31
    s_mul_i32 s54, s54, 3072
    s_add_u32 m0, s52, 28672
    s_add_u32 s54, s54, s50
    buffer_load_dwordx4 v6, s[20:23], s54 offen offset:0 lds
    buffer_load_dwordx4 v6, s[20:23], s54 offen offset:1024 lds
    buffer_load_dwordx4 v6, s[20:23], s54 offen offset:2048 lds
    s_add_u32 s54, s47, 80
    s_and_b32 s54, s54, 511
    s_lshl_b32 s54, s54, 8
    s_add_u32 m0, s51, 32768
    s_add_u32 s54, s54, s48
    buffer_load_dwordx4 v5, s[20:23], s54 offen offset:0 lds
    buffer_load_dwordx4 v5, s[20:23], s54 offen offset:1024 lds
    buffer_load_dwordx4 v5, s[20:23], s54 offen offset:2048 lds
    buffer_load_dwordx4 v5, s[20:23], s54 offen offset:3072 lds
    s_add_u32 s54, s49, 5
    s_and_b32 s54, s54, 31
    s_mul_i32 s54, s54, 3072
    s_add_u32 m0, s52, 31744
    s_add_u32 s54, s54, s50
    buffer_load_dwordx4 v6, s[20:23], s54 offen offset:0 lds
    buffer_load_dwordx4 v6, s[20:23], s54 offen offset:1024 lds
    buffer_load_dwordx4 v6, s[20:23], s54 offen offset:2048 lds
    s_add_u32 s54, s47, 128
    s_and_b32 s54, s54, 511
    s_lshl_b32 s54, s54, 8
    s_add_u32 m0, s51, 57344
    s_add_u32 s54, s54, s48
    buffer_load_dwordx4 v5, s[20:23], s54 offen offset:0 lds
    buffer_load_dwordx4 v5, s[20:23], s54 offen offset:1024 lds
    buffer_load_dwordx4 v5, s[20:23], s54 offen offset:2048 lds
    buffer_load_dwordx4 v5, s[20:23], s54 offen offset:3072 lds
    s_add_u32 s54, s49, 8
    s_and_b32 s54, s54, 31
    s_mul_i32 s54, s54, 3072
    s_add_u32 m0, s52, 57344
    s_add_u32 s54, s54, s50
    buffer_load_dwordx4 v6, s[20:23], s54 offen offset:0 lds
    buffer_load_dwordx4 v6, s[20:23], s54 offen offset:1024 lds
    buffer_load_dwordx4 v6, s[20:23], s54 offen offset:2048 lds
    s_add_u32 s54, s47, 144
    s_and_b32 s54, s54, 511
    s_lshl_b32 s54, s54, 8
    s_add_u32 m0, s51, 61440
    s_add_u32 s54, s54, s48
    buffer_load_dwordx4 v5, s[20:23], s54 offen offset:0 lds
    buffer_load_dwordx4 v5, s[20:23], s54 offen offset:1024 lds
    buffer_load_dwordx4 v5, s[20:23], s54 offen offset:2048 lds
    buffer_load_dwordx4 v5, s[20:23], s54 offen offset:3072 lds
    s_add_u32 s54, s49, 9
    s_and_b32 s54, s54, 31
    s_mul_i32 s54, s54, 3072
    s_add_u32 m0, s52, 60416
    s_add_u32 s54, s54, s50
    buffer_load_dwordx4 v6, s[20:23], s54 offen offset:0 lds
    buffer_load_dwordx4 v6, s[20:23], s54 offen offset:1024 lds
    buffer_load_dwordx4 v6, s[20:23], s54 offen offset:2048 lds
    s_add_u32 s54, s47, 192
    s_and_b32 s54, s54, 511
    s_lshl_b32 s54, s54, 8
    s_add_u32 m0, s51, 86016
    s_add_u32 s54, s54, s48
    buffer_load_dwordx4 v5, s[20:23], s54 offen offset:0 lds
    buffer_load_dwordx4 v5, s[20:23], s54 offen offset:1024 lds
    buffer_load_dwordx4 v5, s[20:23], s54 offen offset:2048 lds
    buffer_load_dwordx4 v5, s[20:23], s54 offen offset:3072 lds
    s_add_u32 s54, s49, 12
    s_and_b32 s54, s54, 31
    s_mul_i32 s54, s54, 3072
    s_add_u32 m0, s52, 86016
    s_add_u32 s54, s54, s50
    buffer_load_dwordx4 v6, s[20:23], s54 offen offset:0 lds
    buffer_load_dwordx4 v6, s[20:23], s54 offen offset:1024 lds
    buffer_load_dwordx4 v6, s[20:23], s54 offen offset:2048 lds
    s_add_u32 s54, s47, 208
    s_and_b32 s54, s54, 511
    s_lshl_b32 s54, s54, 8
    s_add_u32 m0, s51, 90112
    s_add_u32 s54, s54, s48
    buffer_load_dwordx4 v5, s[20:23], s54 offen offset:0 lds
    buffer_load_dwordx4 v5, s[20:23], s54 offen offset:1024 lds
    buffer_load_dwordx4 v5, s[20:23], s54 offen offset:2048 lds
    buffer_load_dwordx4 v5, s[20:23], s54 offen offset:3072 lds
    s_add_u32 s54, s49, 13
    s_and_b32 s54, s54, 31
    s_mul_i32 s54, s54, 3072
    s_add_u32 m0, s52, 89088
    s_add_u32 s54, s54, s50
    buffer_load_dwordx4 v6, s[20:23], s54 offen offset:0 lds
    buffer_load_dwordx4 v6, s[20:23], s54 offen offset:1024 lds
    buffer_load_dwordx4 v6, s[20:23], s54 offen offset:2048 lds
    s_mov_b32 s24, s16
    s_mov_b32 s25, s17
    s_mov_b32 s26, 2097152
    s_mov_b32 s27, 0x20000
    v_lshlrev_b32 v204, 7, v2
    s_lshl_b32 s56, s42, 18
    s_lshl_b32 s57, s43, 13
    s_add_u32 s56, s56, s57
    s_waitcnt vmcnt(42)
    s_barrier
    s_add_u32 s54, s47, 256
    s_and_b32 s54, s54, 511
    s_lshl_b32 s54, s54, 8
    s_add_u32 m0, s51, 114688
    s_add_u32 s54, s54, s48
    buffer_load_dwordx4 v5, s[20:23], s54 offen offset:0 lds
    buffer_load_dwordx4 v5, s[20:23], s54 offen offset:1024 lds
    buffer_load_dwordx4 v5, s[20:23], s54 offen offset:2048 lds
    buffer_load_dwordx4 v5, s[20:23], s54 offen offset:3072 lds
    s_add_u32 s54, s49, 16
    s_and_b32 s54, s54, 31
    s_mul_i32 s54, s54, 3072
    s_add_u32 m0, s52, 114688
    s_add_u32 s54, s54, s50
    buffer_load_dwordx4 v6, s[20:23], s54 offen offset:0 lds
    buffer_load_dwordx4 v6, s[20:23], s54 offen offset:1024 lds
    buffer_load_dwordx4 v6, s[20:23], s54 offen offset:2048 lds
    s_add_u32 s54, s47, 272
    s_and_b32 s54, s54, 511
    s_lshl_b32 s54, s54, 8
    s_add_u32 m0, s51, 118784
    s_add_u32 s54, s54, s48
    buffer_load_dwordx4 v5, s[20:23], s54 offen offset:0 lds
    buffer_load_dwordx4 v5, s[20:23], s54 offen offset:1024 lds
    buffer_load_dwordx4 v5, s[20:23], s54 offen offset:2048 lds
    buffer_load_dwordx4 v5, s[20:23], s54 offen offset:3072 lds
    s_add_u32 s54, s49, 17
    s_and_b32 s54, s54, 31
    s_mul_i32 s54, s54, 3072
    s_add_u32 m0, s52, 117760
    s_add_u32 s54, s54, s50
    buffer_load_dwordx4 v6, s[20:23], s54 offen offset:0 lds
    buffer_load_dwordx4 v6, s[20:23], s54 offen offset:1024 lds
    buffer_load_dwordx4 v6, s[20:23], s54 offen offset:2048 lds
    s_waitcnt vmcnt(42)
    s_barrier
    s_add_u32 s54, s47, 320
    s_and_b32 s54, s54, 511
    s_lshl_b32 s54, s54, 8
    s_add_u32 m0, s51, 0
    s_add_u32 s54, s54, s48
    buffer_load_dwordx4 v5, s[20:23], s54 offen offset:0 lds
    buffer_load_dwordx4 v5, s[20:23], s54 offen offset:1024 lds
    buffer_load_dwordx4 v5, s[20:23], s54 offen offset:2048 lds
    buffer_load_dwordx4 v5, s[20:23], s54 offen offset:3072 lds
    s_add_u32 s54, s49, 20
    s_and_b32 s54, s54, 31
    s_mul_i32 s54, s54, 3072
    s_add_u32 m0, s52, 0
    s_add_u32 s54, s54, s50
    buffer_load_dwordx4 v6, s[20:23], s54 offen offset:0 lds
    buffer_load_dwordx4 v6, s[20:23], s54 offen offset:1024 lds
    buffer_load_dwordx4 v6, s[20:23], s54 offen offset:2048 lds
    s_add_u32 s54, s47, 336
    s_and_b32 s54, s54, 511
    s_lshl_b32 s54, s54, 8
    s_add_u32 m0, s51, 4096
    s_add_u32 s54, s54, s48
    buffer_load_dwordx4 v5, s[20:23], s54 offen offset:0 lds
    buffer_load_dwordx4 v5, s[20:23], s54 offen offset:1024 lds
    buffer_load_dwordx4 v5, s[20:23], s54 offen offset:2048 lds
    buffer_load_dwordx4 v5, s[20:23], s54 offen offset:3072 lds
    s_add_u32 s54, s49, 21
    s_and_b32 s54, s54, 31
    s_mul_i32 s54, s54, 3072
    s_add_u32 m0, s52, 3072
    s_add_u32 s54, s54, s50
    buffer_load_dwordx4 v6, s[20:23], s54 offen offset:0 lds
    buffer_load_dwordx4 v6, s[20:23], s54 offen offset:1024 lds
    buffer_load_dwordx4 v6, s[20:23], s54 offen offset:2048 lds
    s_waitcnt vmcnt(42)
    s_barrier
    s_add_u32 s54, s47, 384
    s_and_b32 s54, s54, 511
    s_lshl_b32 s54, s54, 8
    s_add_u32 m0, s51, 28672
    s_add_u32 s54, s54, s48
    buffer_load_dwordx4 v5, s[20:23], s54 offen offset:0 lds
    buffer_load_dwordx4 v5, s[20:23], s54 offen offset:1024 lds
    buffer_load_dwordx4 v5, s[20:23], s54 offen offset:2048 lds
    buffer_load_dwordx4 v5, s[20:23], s54 offen offset:3072 lds
    s_add_u32 s54, s49, 24
    s_and_b32 s54, s54, 31
    s_mul_i32 s54, s54, 3072
    s_add_u32 m0, s52, 28672
    s_add_u32 s54, s54, s50
    buffer_load_dwordx4 v6, s[20:23], s54 offen offset:0 lds
    buffer_load_dwordx4 v6, s[20:23], s54 offen offset:1024 lds
    buffer_load_dwordx4 v6, s[20:23], s54 offen offset:2048 lds
    s_add_u32 s54, s47, 400
    s_and_b32 s54, s54, 511
    s_lshl_b32 s54, s54, 8
    s_add_u32 m0, s51, 32768
    s_add_u32 s54, s54, s48
    buffer_load_dwordx4 v5, s[20:23], s54 offen offset:0 lds
    buffer_load_dwordx4 v5, s[20:23], s54 offen offset:1024 lds
    buffer_load_dwordx4 v5, s[20:23], s54 offen offset:2048 lds
    buffer_load_dwordx4 v5, s[20:23], s54 offen offset:3072 lds
    s_add_u32 s54, s49, 25
    s_and_b32 s54, s54, 31
    s_mul_i32 s54, s54, 3072
    s_add_u32 m0, s52, 31744
    s_add_u32 s54, s54, s50
    buffer_load_dwordx4 v6, s[20:23], s54 offen offset:0 lds
    buffer_load_dwordx4 v6, s[20:23], s54 offen offset:1024 lds
    buffer_load_dwordx4 v6, s[20:23], s54 offen offset:2048 lds
    s_waitcnt vmcnt(42)
    s_barrier
    s_add_u32 s54, s47, 448
    s_and_b32 s54, s54, 511
    s_lshl_b32 s54, s54, 8
    s_add_u32 m0, s51, 57344
    s_add_u32 s54, s54, s48
    buffer_load_dwordx4 v5, s[20:23], s54 offen offset:0 lds
    buffer_load_dwordx4 v5, s[20:23], s54 offen offset:1024 lds
    buffer_load_dwordx4 v5, s[20:23], s54 offen offset:2048 lds
    buffer_load_dwordx4 v5, s[20:23], s54 offen offset:3072 lds
    s_add_u32 s54, s49, 28
    s_and_b32 s54, s54, 31
    s_mul_i32 s54, s54, 3072
    s_add_u32 m0, s52, 57344
    s_add_u32 s54, s54, s50
    buffer_load_dwordx4 v6, s[20:23], s54 offen offset:0 lds
    buffer_load_dwordx4 v6, s[20:23], s54 offen offset:1024 lds
    buffer_load_dwordx4 v6, s[20:23], s54 offen offset:2048 lds
    s_add_u32 s54, s47, 464
    s_and_b32 s54, s54, 511
    s_lshl_b32 s54, s54, 8
    s_add_u32 m0, s51, 61440
    s_add_u32 s54, s54, s48
    buffer_load_dwordx4 v5, s[20:23], s54 offen offset:0 lds
    buffer_load_dwordx4 v5, s[20:23], s54 offen offset:1024 lds
    buffer_load_dwordx4 v5, s[20:23], s54 offen offset:2048 lds
    buffer_load_dwordx4 v5, s[20:23], s54 offen offset:3072 lds
    s_add_u32 s54, s49, 29
    s_and_b32 s54, s54, 31
    s_mul_i32 s54, s54, 3072
    s_add_u32 m0, s52, 60416
    s_add_u32 s54, s54, s50
    buffer_load_dwordx4 v6, s[20:23], s54 offen offset:0 lds
    buffer_load_dwordx4 v6, s[20:23], s54 offen offset:1024 lds
    buffer_load_dwordx4 v6, s[20:23], s54 offen offset:2048 lds
    s_mov_b32 m0, 143360
    s_nop 0
    buffer_load_dwordx4 v6, s[20:23], s53 offen lds
    s_lshl_b32 s54, s2, 11
    s_lshl_b32 s55, s41, 9
    s_add_u32 s54, s54, s55
    s_add_u32 s54, s54, 8388608
    buffer_load_dwordx4 v[200:203], v6, s[20:23], s54 offen
    buffer_load_dword v205, v204, s[24:27], s56 offen
    s_waitcnt vmcnt(45)
    s_barrier
    s_waitcnt vmcnt(31)
    s_barrier
    s_waitcnt vmcnt(17)
    s_barrier
    s_waitcnt vmcnt(2)
    s_barrier
    s_lshr_b32 s41, s41, 1
    v_and_b32 v5, 15, v2
    v_lshrrev_b32 v6, 2, v5
    v_lshl_add_u32 v6, v7, 3, v6
    v_mul_u32_u24 v6, 336, v6
    v_bfe_u32 v9, v2, 4, 1
    v_lshl_add_u32 v6, v9, 5, v6
    v_and_b32 v5, 3, v5
    v_lshl_add_u32 v6, v5, 3, v6
    s_lshl_b32 s55, s41, 6
    v_add_u32 v6, s55, v6
    s_barrier
    ds_read_b64_tr_b16 v[128:129], v6 offset:128
    ds_read_b64_tr_b16 v[132:133], v6 offset:0
    ds_read_b64_tr_b16 v[130:131], v6 offset:1472
    ds_read_b64_tr_b16 v[134:135], v6 offset:1344
    ds_read_b64_tr_b16 v[136:137], v6 offset:5504
    ds_read_b64_tr_b16 v[140:141], v6 offset:5376
    ds_read_b64_tr_b16 v[138:139], v6 offset:6848
    ds_read_b64_tr_b16 v[142:143], v6 offset:6720
    ds_read_b64_tr_b16 v[144:145], v6 offset:10880
    ds_read_b64_tr_b16 v[148:149], v6 offset:10752
    ds_read_b64_tr_b16 v[146:147], v6 offset:12224
    ds_read_b64_tr_b16 v[150:151], v6 offset:12096
    s_waitcnt lgkmcnt(8)
    v_mfma_f32_32x32x16_bf16 v[36:51], v[128:131], v[132:135], 0
    ds_read_b64_tr_b16 v[152:153], v6 offset:16256
    ds_read_b64_tr_b16 v[156:157], v6 offset:16128
    ds_read_b64_tr_b16 v[154:155], v6 offset:17600
    ds_read_b64_tr_b16 v[158:159], v6 offset:17472
    s_waitcnt lgkmcnt(8)
    v_mfma_f32_32x32x16_bf16 v[36:51], v[136:139], v[140:143], v[36:51]
    ds_read_b64_tr_b16 v[160:161], v6 offset:21632
    ds_read_b64_tr_b16 v[164:165], v6 offset:21504
    ds_read_b64_tr_b16 v[162:163], v6 offset:22976
    ds_read_b64_tr_b16 v[166:167], v6 offset:22848
    s_waitcnt lgkmcnt(8)
    v_mfma_f32_32x32x16_bf16 v[36:51], v[144:147], v[148:151], v[36:51]
    ds_read_b64_tr_b16 v[168:169], v6 offset:27008
    ds_read_b64_tr_b16 v[172:173], v6 offset:26880
    ds_read_b64_tr_b16 v[170:171], v6 offset:28352
    ds_read_b64_tr_b16 v[174:175], v6 offset:28224
    s_waitcnt lgkmcnt(8)
    v_mfma_f32_32x32x16_bf16 v[36:51], v[152:155], v[156:159], v[36:51]
    ds_read_b64_tr_b16 v[176:177], v6 offset:32384
    ds_read_b64_tr_b16 v[180:181], v6 offset:32256
    ds_read_b64_tr_b16 v[178:179], v6 offset:33728
    ds_read_b64_tr_b16 v[182:183], v6 offset:33600
    s_waitcnt lgkmcnt(8)
    v_mfma_f32_32x32x16_bf16 v[36:51], v[160:163], v[164:167], v[36:51]
    ds_read_b64_tr_b16 v[184:185], v6 offset:37760
    ds_read_b64_tr_b16 v[188:189], v6 offset:37632
    ds_read_b64_tr_b16 v[186:187], v6 offset:39104
    ds_read_b64_tr_b16 v[190:191], v6 offset:38976
    s_waitcnt lgkmcnt(8)
    v_mfma_f32_32x32x16_bf16 v[36:51], v[168:171], v[172:175], v[36:51]
    s_waitcnt lgkmcnt(4)
    v_mfma_f32_32x32x16_bf16 v[36:51], v[176:179], v[180:183], v[36:51]
    s_waitcnt lgkmcnt(0)
    v_mfma_f32_32x32x16_bf16 v[36:51], v[184:187], v[188:191], v[36:51]
    v_lshlrev_b32 v5, 2, v8
    v_lshl_add_u32 v5, v7, 9, v5
    s_lshl_b32 s55, s45, 1
    s_add_u32 s55, s55, s41
    s_mul_i32 s55, s55, 2176
    s_add_u32 s55, s55, 25296896
    s_nop 7
    buffer_atomic_add_f32 v36, v5, s[20:23], s55 offen offset:0
    buffer_atomic_add_f32 v37, v5, s[20:23], s55 offen offset:128
    buffer_atomic_add_f32 v38, v5, s[20:23], s55 offen offset:256
    buffer_atomic_add_f32 v39, v5, s[20:23], s55 offen offset:384
    buffer_atomic_add_f32 v40, v5, s[20:23], s55 offen offset:1024
    buffer_atomic_add_f32 v41, v5, s[20:23], s55 offen offset:1152
    buffer_atomic_add_f32 v42, v5, s[20:23], s55 offen offset:1280
    buffer_atomic_add_f32 v43, v5, s[20:23], s55 offen offset:1408
    s_mov_b32 exec_hi, 0
    buffer_atomic_add_f32 v44, v5, s[20:23], s55 offen offset:2048
    s_endpgm
K5_C:
    v_lshrrev_b32 v16, 2, v4
    v_lshl_add_u32 v17, v7, 3, v16
    v_lshlrev_b32 v17, 8, v17
    v_xor_b32 v16, s41, v16
    v_lshl_add_u32 v17, v16, 6, v17
    v_and_b32 v16, 1, v3
    v_lshl_add_u32 v17, v16, 5, v17
    v_and_b32 v16, 3, v4
    v_lshl_add_u32 v10, v16, 3, v17
    v_add_u32 v11, 57344, v10
    v_add_u32 v12, 114688, v10
    v_add_u32 v13, 16384, v6
    v_add_u32 v14, 73728, v6
    v_add_u32 v15, 131072, v6
    v_lshrrev_b32 v16, 2, v4
    v_lshl_add_u32 v17, v3, 3, v16
    v_lshlrev_b32 v17, 8, v17
    v_xor_b32 v16, s41, v16
    v_lshl_add_u32 v17, v16, 6, v17
    v_and_b32 v16, 3, v4
    v_lshl_add_u32 v16, v16, 3, v17
    v_add_u32 v17, 57344, v16
    v_add_u32 v19, 114688, v16
    v_add_u32 v9, 143360, v9
    v_mov_b32 v252, 0x3f803f80
    v_mov_b32 v253, 0x3f803f80
    v_mov_b32 v254, 0x3f803f80
    v_mov_b32 v255, 0x3f803f80
    v_lshlrev_b32 v3, 5, v8
    v_lshl_add_u32 v3, v7, 4, v3
    s_lshl_b32 s54, s44, 17
    s_lshl_b32 s55, s41, 15
    s_add_u32 s54, s54, s55
    s_lshl_b32 s55, s45, 11
    s_add_u32 s54, s54, s55
    s_add_u32 s54, s54, 17825792
    s_waitcnt lgkmcnt(0)
    s_barrier
    ds_read_b64_tr_b16 v[68:69], v10 offset:0
    ds_read_b64_tr_b16 v[70:71], v10 offset:1024
    ds_read_b128 v[72:75], v13 offset:0
    ds_read_b64_tr_b16 v[196:197], v16 offset:0
    ds_read_b64_tr_b16 v[198:199], v16 offset:1024
    ds_read_b128 v[76:79], v13 offset:1024
    ds_read_b128 v[80:83], v13 offset:2048
    ds_read_b64_tr_b16 v[84:85], v10 offset:4096
    ds_read_b64_tr_b16 v[86:87], v10 offset:5120
    ds_read_b128 v[88:91], v13 offset:3072
    ds_read_b64_tr_b16 v[200:201], v16 offset:32
    ds_read_b64_tr_b16 v[202:203], v16 offset:1056
    ds_read_b128 v[92:95], v13 offset:4096
    ds_read_b128 v[96:99], v13 offset:5120
    ds_read_b64_tr_b16 v[100:101], v10 offset:8192
    ds_read_b64_tr_b16 v[102:103], v10 offset:9216
    ds_read_b128 v[104:107], v13 offset:6144
    ds_read_b64_tr_b16 v[204:205], v16 offset:8192
    ds_read_b64_tr_b16 v[206:207], v16 offset:9216
    ds_read_b128 v[108:111], v13 offset:7168
    ds_read_b128 v[112:115], v13 offset:8192
    ds_read_b64_tr_b16 v[116:117], v10 offset:12288
    ds_read_b64_tr_b16 v[118:119], v10 offset:13312
    ds_read_b128 v[120:123], v13 offset:9216
    ds_read_b64_tr_b16 v[208:209], v16 offset:8224
    ds_read_b64_tr_b16 v[210:211], v16 offset:9248
    ds_read_b128 v[124:127], v13 offset:10240
    ds_read_b128 v[128:131], v13 offset:11264
    s_waitcnt lgkmcnt(0)
    s_barrier
    v_mfma_f32_32x32x16_bf16 v[36:51], v[76:79], v[68:71], 0
    ds_read_b64_tr_b16 v[132:133], v10 offset:28672
    ds_read_b64_tr_b16 v[134:135], v10 offset:29696
    ds_read_b128 v[136:139], v13 offset:28672
    v_mfma_f32_32x32x16_bf16 v[52:67], v[80:83], v[68:71], 0
    ds_read_b64_tr_b16 v[212:213], v16 offset:28672
    ds_read_b64_tr_b16 v[214:215], v16 offset:29696
    ds_read_b128 v[140:143], v13 offset:29696
    v_mfma_f32_16x16x32_bf16 v[228:231], v[196:199], v[196:199], 0
    v_mfma_f32_32x32x16_bf16 v[20:35], v[72:75], v[68:71], 0
    ds_read_b128 v[144:147], v13 offset:30720
    v_mfma_f32_16x16x32_bf16 v[236:239], v[252:255], v[196:199], 0
    v_mov_b32 v244, v68
    v_mov_b32 v245, v69
    v_mov_b32 v246, v70
    v_mov_b32 v247, v71
    v_mfma_f32_32x32x16_bf16 v[36:51], v[92:95], v[84:87], v[36:51]
    ds_read_b64_tr_b16 v[148:149], v10 offset:32768
    ds_read_b64_tr_b16 v[150:151], v10 offset:33792
    ds_read_b128 v[152:155], v13 offset:31744
    v_mfma_f32_32x32x16_bf16 v[52:67], v[96:99], v[84:87], v[52:67]
    ds_read_b64_tr_b16 v[216:217], v16 offset:28704
    ds_read_b64_tr_b16 v[218:219], v16 offset:29728
    ds_read_b128 v[156:159], v13 offset:32768
    v_mfma_f32_16x16x32_bf16 v[232:235], v[200:203], v[200:203], 0
    v_mfma_f32_32x32x16_bf16 v[20:35], v[88:91], v[84:87], v[20:35]
    ds_read_b128 v[160:163], v13 offset:33792
    v_mfma_f32_16x16x32_bf16 v[240:243], v[252:255], v[200:203], 0
    v_mov_b32 v248, v84
    v_mov_b32 v249, v85
    v_mov_b32 v250, v86
    v_mov_b32 v251, v87
    v_mfma_f32_32x32x16_bf16 v[36:51], v[108:111], v[100:103], v[36:51]
    ds_read_b64_tr_b16 v[164:165], v10 offset:36864
    ds_read_b64_tr_b16 v[166:167], v10 offset:37888
    ds_read_b128 v[168:171], v13 offset:34816
    v_mfma_f32_32x32x16_bf16 v[52:67], v[112:115], v[100:103], v[52:67]
    ds_read_b64_tr_b16 v[220:221], v16 offset:36864
    ds_read_b64_tr_b16 v[222:223], v16 offset:37888
    ds_read_b128 v[172:175], v13 offset:35840
    v_mfma_f32_16x16x32_bf16 v[228:231], v[204:207], v[204:207], v[228:231]
    v_mfma_f32_32x32x16_bf16 v[20:35], v[104:107], v[100:103], v[20:35]
    ds_read_b128 v[176:179], v13 offset:36864
    v_mfma_f32_16x16x32_bf16 v[236:239], v[252:255], v[204:207], v[236:239]
    v_mfma_f32_32x32x16_bf16 v[36:51], v[124:127], v[116:119], v[36:51]
    ds_read_b64_tr_b16 v[180:181], v10 offset:40960
    ds_read_b64_tr_b16 v[182:183], v10 offset:41984
    ds_read_b128 v[184:187], v13 offset:37888
    v_mfma_f32_32x32x16_bf16 v[52:67], v[128:131], v[116:119], v[52:67]
    ds_read_b64_tr_b16 v[224:225], v16 offset:36896
    ds_read_b64_tr_b16 v[226:227], v16 offset:37920
    ds_read_b128 v[188:191], v13 offset:38912
    v_mfma_f32_16x16x32_bf16 v[232:235], v[208:211], v[208:211], v[232:235]
    v_mfma_f32_32x32x16_bf16 v[20:35], v[120:123], v[116:119], v[20:35]
    ds_read_b128 v[192:195], v13 offset:39936
    v_mfma_f32_16x16x32_bf16 v[240:243], v[252:255], v[208:211], v[240:243]
    s_waitcnt lgkmcnt(0)
    s_barrier
    v_mfma_f32_32x32x16_bf16 v[36:51], v[140:143], v[132:135], v[36:51]
    ds_read_b64_tr_b16 v[68:69], v11 offset:0
    ds_read_b64_tr_b16 v[70:71], v11 offset:1024
    ds_read_b128 v[72:75], v14 offset:0
    v_mfma_f32_32x32x16_bf16 v[52:67], v[144:147], v[132:135], v[52:67]
    ds_read_b64_tr_b16 v[196:197], v17 offset:0
    ds_read_b64_tr_b16 v[198:199], v17 offset:1024
    ds_read_b128 v[76:79], v14 offset:1024
    v_mfma_f32_16x16x32_bf16 v[228:231], v[212:215], v[212:215], v[228:231]
    v_mfma_f32_32x32x16_bf16 v[20:35], v[136:139], v[132:135], v[20:35]
    ds_read_b128 v[80:83], v14 offset:2048
    v_mfma_f32_16x16x32_bf16 v[236:239], v[252:255], v[212:215], v[236:239]
    v_mfma_f32_32x32x16_bf16 v[36:51], v[156:159], v[148:151], v[36:51]
    ds_read_b64_tr_b16 v[84:85], v11 offset:4096
    ds_read_b64_tr_b16 v[86:87], v11 offset:5120
    ds_read_b128 v[88:91], v14 offset:3072
    v_mfma_f32_32x32x16_bf16 v[52:67], v[160:163], v[148:151], v[52:67]
    ds_read_b64_tr_b16 v[200:201], v17 offset:32
    ds_read_b64_tr_b16 v[202:203], v17 offset:1056
    ds_read_b128 v[92:95], v14 offset:4096
    v_mfma_f32_16x16x32_bf16 v[232:235], v[216:219], v[216:219], v[232:235]
    v_mfma_f32_32x32x16_bf16 v[20:35], v[152:155], v[148:151], v[20:35]
    ds_read_b128 v[96:99], v14 offset:5120
    v_mfma_f32_16x16x32_bf16 v[240:243], v[252:255], v[216:219], v[240:243]
    v_mfma_f32_32x32x16_bf16 v[36:51], v[172:175], v[164:167], v[36:51]
    ds_read_b64_tr_b16 v[100:101], v11 offset:8192
    ds_read_b64_tr_b16 v[102:103], v11 offset:9216
    ds_read_b128 v[104:107], v14 offset:6144
    v_mfma_f32_32x32x16_bf16 v[52:67], v[176:179], v[164:167], v[52:67]
    ds_read_b64_tr_b16 v[204:205], v17 offset:8192
    ds_read_b64_tr_b16 v[206:207], v17 offset:9216
    ds_read_b128 v[108:111], v14 offset:7168
    v_mfma_f32_16x16x32_bf16 v[228:231], v[220:223], v[220:223], v[228:231]
    v_mfma_f32_32x32x16_bf16 v[20:35], v[168:171], v[164:167], v[20:35]
    ds_read_b128 v[112:115], v14 offset:8192
    v_mfma_f32_16x16x32_bf16 v[236:239], v[252:255], v[220:223], v[236:239]
    v_mfma_f32_32x32x16_bf16 v[36:51], v[188:191], v[180:183], v[36:51]
    ds_read_b64_tr_b16 v[116:117], v11 offset:12288
    ds_read_b64_tr_b16 v[118:119], v11 offset:13312
    ds_read_b128 v[120:123], v14 offset:9216
    v_mfma_f32_32x32x16_bf16 v[52:67], v[192:195], v[180:183], v[52:67]
    ds_read_b64_tr_b16 v[208:209], v17 offset:8224
    ds_read_b64_tr_b16 v[210:211], v17 offset:9248
    ds_read_b128 v[124:127], v14 offset:10240
    v_mfma_f32_16x16x32_bf16 v[232:235], v[224:227], v[224:227], v[232:235]
    v_mfma_f32_32x32x16_bf16 v[20:35], v[184:187], v[180:183], v[20:35]
    ds_read_b128 v[128:131], v14 offset:11264
    v_mfma_f32_16x16x32_bf16 v[240:243], v[252:255], v[224:227], v[240:243]
    s_waitcnt lgkmcnt(0)
    s_barrier
    v_mfma_f32_32x32x16_bf16 v[36:51], v[76:79], v[68:71], v[36:51]
    ds_read_b64_tr_b16 v[132:133], v11 offset:28672
    ds_read_b64_tr_b16 v[134:135], v11 offset:29696
    ds_read_b128 v[136:139], v14 offset:28672
    v_mfma_f32_32x32x16_bf16 v[52:67], v[80:83], v[68:71], v[52:67]
    ds_read_b64_tr_b16 v[212:213], v17 offset:28672
    ds_read_b64_tr_b16 v[214:215], v17 offset:29696
    ds_read_b128 v[140:143], v14 offset:29696
    v_mfma_f32_16x16x32_bf16 v[228:231], v[196:199], v[196:199], v[228:231]
    v_mfma_f32_32x32x16_bf16 v[20:35], v[72:75], v[68:71], v[20:35]
    ds_read_b128 v[144:147], v14 offset:30720
    v_mfma_f32_16x16x32_bf16 v[236:239], v[252:255], v[196:199], v[236:239]
    v_mfma_f32_32x32x16_bf16 v[36:51], v[92:95], v[84:87], v[36:51]
    ds_read_b64_tr_b16 v[148:149], v11 offset:32768
    ds_read_b64_tr_b16 v[150:151], v11 offset:33792
    ds_read_b128 v[152:155], v14 offset:31744
    v_mfma_f32_32x32x16_bf16 v[52:67], v[96:99], v[84:87], v[52:67]
    ds_read_b64_tr_b16 v[216:217], v17 offset:28704
    ds_read_b64_tr_b16 v[218:219], v17 offset:29728
    ds_read_b128 v[156:159], v14 offset:32768
    v_mfma_f32_16x16x32_bf16 v[232:235], v[200:203], v[200:203], v[232:235]
    v_mfma_f32_32x32x16_bf16 v[20:35], v[88:91], v[84:87], v[20:35]
    ds_read_b128 v[160:163], v14 offset:33792
    v_mfma_f32_16x16x32_bf16 v[240:243], v[252:255], v[200:203], v[240:243]
    v_mfma_f32_32x32x16_bf16 v[36:51], v[108:111], v[100:103], v[36:51]
    ds_read_b64_tr_b16 v[164:165], v11 offset:36864
    ds_read_b64_tr_b16 v[166:167], v11 offset:37888
    ds_read_b128 v[168:171], v14 offset:34816
    v_mfma_f32_32x32x16_bf16 v[52:67], v[112:115], v[100:103], v[52:67]
    ds_read_b64_tr_b16 v[220:221], v17 offset:36864
    ds_read_b64_tr_b16 v[222:223], v17 offset:37888
    ds_read_b128 v[172:175], v14 offset:35840
    v_mfma_f32_16x16x32_bf16 v[228:231], v[204:207], v[204:207], v[228:231]
    v_mfma_f32_32x32x16_bf16 v[20:35], v[104:107], v[100:103], v[20:35]
    ds_read_b128 v[176:179], v14 offset:36864
    v_mfma_f32_16x16x32_bf16 v[236:239], v[252:255], v[204:207], v[236:239]
    v_mfma_f32_32x32x16_bf16 v[36:51], v[124:127], v[116:119], v[36:51]
    ds_read_b64_tr_b16 v[180:181], v11 offset:40960
    ds_read_b64_tr_b16 v[182:183], v11 offset:41984
    ds_read_b128 v[184:187], v14 offset:37888
    v_mfma_f32_32x32x16_bf16 v[52:67], v[128:131], v[116:119], v[52:67]
    ds_read_b64_tr_b16 v[224:225], v17 offset:36896
    ds_read_b64_tr_b16 v[226:227], v17 offset:37920
    ds_read_b128 v[188:191], v14 offset:38912
    v_mfma_f32_16x16x32_bf16 v[232:235], v[208:211], v[208:211], v[232:235]
    v_mfma_f32_32x32x16_bf16 v[20:35], v[120:123], v[116:119], v[20:35]
    ds_read_b128 v[192:195], v14 offset:39936
    v_mfma_f32_16x16x32_bf16 v[240:243], v[252:255], v[208:211], v[240:243]
    s_waitcnt lgkmcnt(0)
    s_barrier
    v_mfma_f32_32x32x16_bf16 v[36:51], v[140:143], v[132:135], v[36:51]
    ds_read_b64_tr_b16 v[68:69], v12 offset:0
    ds_read_b64_tr_b16 v[70:71], v12 offset:1024
    ds_read_b128 v[72:75], v15 offset:0
    v_mfma_f32_32x32x16_bf16 v[52:67], v[144:147], v[132:135], v[52:67]
    ds_read_b64_tr_b16 v[196:197], v19 offset:0
    ds_read_b64_tr_b16 v[198:199], v19 offset:1024
    ds_read_b128 v[76:79], v15 offset:1024
    v_mfma_f32_16x16x32_bf16 v[228:231], v[212:215], v[212:215], v[228:231]
    v_mfma_f32_32x32x16_bf16 v[20:35], v[136:139], v[132:135], v[20:35]
    ds_read_b128 v[80:83], v15 offset:2048
    v_mfma_f32_16x16x32_bf16 v[236:239], v[252:255], v[212:215], v[236:239]
    v_mfma_f32_32x32x16_bf16 v[36:51], v[156:159], v[148:151], v[36:51]
    ds_read_b64_tr_b16 v[84:85], v12 offset:4096
    ds_read_b64_tr_b16 v[86:87], v12 offset:5120
    ds_read_b128 v[88:91], v15 offset:3072
    v_mfma_f32_32x32x16_bf16 v[52:67], v[160:163], v[148:151], v[52:67]
    ds_read_b64_tr_b16 v[200:201], v19 offset:32
    ds_read_b64_tr_b16 v[202:203], v19 offset:1056
    ds_read_b128 v[92:95], v15 offset:4096
    v_mfma_f32_16x16x32_bf16 v[232:235], v[216:219], v[216:219], v[232:235]
    v_mfma_f32_32x32x16_bf16 v[20:35], v[152:155], v[148:151], v[20:35]
    ds_read_b128 v[96:99], v15 offset:5120
    v_mfma_f32_16x16x32_bf16 v[240:243], v[252:255], v[216:219], v[240:243]
    v_mfma_f32_32x32x16_bf16 v[36:51], v[172:175], v[164:167], v[36:51]
    ds_read_b64_tr_b16 v[100:101], v12 offset:8192
    ds_read_b64_tr_b16 v[102:103], v12 offset:9216
    ds_read_b128 v[104:107], v15 offset:6144
    v_mfma_f32_32x32x16_bf16 v[52:67], v[176:179], v[164:167], v[52:67]
    ds_read_b64_tr_b16 v[204:205], v19 offset:8192
    ds_read_b64_tr_b16 v[206:207], v19 offset:9216
    ds_read_b128 v[108:111], v15 offset:7168
    v_mfma_f32_16x16x32_bf16 v[228:231], v[220:223], v[220:223], v[228:231]
    v_mfma_f32_32x32x16_bf16 v[20:35], v[168:171], v[164:167], v[20:35]
    ds_read_b128 v[112:115], v15 offset:8192
    v_mfma_f32_16x16x32_bf16 v[236:239], v[252:255], v[220:223], v[236:239]
    v_mfma_f32_32x32x16_bf16 v[36:51], v[188:191], v[180:183], v[36:51]
    ds_read_b64_tr_b16 v[116:117], v12 offset:12288
    ds_read_b64_tr_b16 v[118:119], v12 offset:13312
    ds_read_b128 v[120:123], v15 offset:9216
    v_mfma_f32_32x32x16_bf16 v[52:67], v[192:195], v[180:183], v[52:67]
    ds_read_b64_tr_b16 v[208:209], v19 offset:8224
    ds_read_b64_tr_b16 v[210:211], v19 offset:9248
    ds_read_b128 v[124:127], v15 offset:10240
    v_mfma_f32_16x16x32_bf16 v[232:235], v[224:227], v[224:227], v[232:235]
    v_mfma_f32_32x32x16_bf16 v[20:35], v[184:187], v[180:183], v[20:35]
    ds_read_b128 v[128:131], v15 offset:11264
    v_mfma_f32_16x16x32_bf16 v[240:243], v[252:255], v[224:227], v[240:243]
    s_waitcnt lgkmcnt(0)
    s_barrier
    v_mfma_f32_32x32x16_bf16 v[36:51], v[76:79], v[68:71], v[36:51]
    ds_read_b64_tr_b16 v[132:133], v10 offset:0
    ds_read_b64_tr_b16 v[134:135], v10 offset:1024
    ds_read_b128 v[136:139], v13 offset:0
    v_mfma_f32_32x32x16_bf16 v[52:67], v[80:83], v[68:71], v[52:67]
    ds_read_b64_tr_b16 v[212:213], v16 offset:0
    ds_read_b64_tr_b16 v[214:215], v16 offset:1024
    ds_read_b128 v[140:143], v13 offset:1024
    v_mfma_f32_16x16x32_bf16 v[228:231], v[196:199], v[196:199], v[228:231]
    v_mfma_f32_32x32x16_bf16 v[20:35], v[72:75], v[68:71], v[20:35]
    ds_read_b128 v[144:147], v13 offset:2048
    v_mfma_f32_16x16x32_bf16 v[236:239], v[252:255], v[196:199], v[236:239]
    v_mfma_f32_32x32x16_bf16 v[36:51], v[92:95], v[84:87], v[36:51]
    ds_read_b64_tr_b16 v[148:149], v10 offset:4096
    ds_read_b64_tr_b16 v[150:151], v10 offset:5120
    ds_read_b128 v[152:155], v13 offset:3072
    v_mfma_f32_32x32x16_bf16 v[52:67], v[96:99], v[84:87], v[52:67]
    ds_read_b64_tr_b16 v[216:217], v16 offset:32
    ds_read_b64_tr_b16 v[218:219], v16 offset:1056
    ds_read_b128 v[156:159], v13 offset:4096
    v_mfma_f32_16x16x32_bf16 v[232:235], v[200:203], v[200:203], v[232:235]
    v_mfma_f32_32x32x16_bf16 v[20:35], v[88:91], v[84:87], v[20:35]
    ds_read_b128 v[160:163], v13 offset:5120
    v_mfma_f32_16x16x32_bf16 v[240:243], v[252:255], v[200:203], v[240:243]
    v_mfma_f32_32x32x16_bf16 v[36:51], v[108:111], v[100:103], v[36:51]
    ds_read_b64_tr_b16 v[164:165], v10 offset:8192
    ds_read_b64_tr_b16 v[166:167], v10 offset:9216
    ds_read_b128 v[168:171], v13 offset:6144
    v_mfma_f32_32x32x16_bf16 v[52:67], v[112:115], v[100:103], v[52:67]
    ds_read_b64_tr_b16 v[220:221], v16 offset:8192
    ds_read_b64_tr_b16 v[222:223], v16 offset:9216
    ds_read_b128 v[172:175], v13 offset:7168
    v_mfma_f32_16x16x32_bf16 v[228:231], v[204:207], v[204:207], v[228:231]
    v_mfma_f32_32x32x16_bf16 v[20:35], v[104:107], v[100:103], v[20:35]
    ds_read_b128 v[176:179], v13 offset:8192
    v_mfma_f32_16x16x32_bf16 v[236:239], v[252:255], v[204:207], v[236:239]
    v_mfma_f32_32x32x16_bf16 v[36:51], v[124:127], v[116:119], v[36:51]
    ds_read_b64_tr_b16 v[180:181], v10 offset:12288
    ds_read_b64_tr_b16 v[182:183], v10 offset:13312
    ds_read_b128 v[184:187], v13 offset:9216
    v_mfma_f32_32x32x16_bf16 v[52:67], v[128:131], v[116:119], v[52:67]
    ds_read_b64_tr_b16 v[224:225], v16 offset:8224
    ds_read_b64_tr_b16 v[226:227], v16 offset:9248
    ds_read_b128 v[188:191], v13 offset:10240
    v_mfma_f32_16x16x32_bf16 v[232:235], v[208:211], v[208:211], v[232:235]
    v_mfma_f32_32x32x16_bf16 v[20:35], v[120:123], v[116:119], v[20:35]
    ds_read_b128 v[192:195], v13 offset:11264
    v_mfma_f32_16x16x32_bf16 v[240:243], v[252:255], v[208:211], v[240:243]
    s_waitcnt lgkmcnt(0)
    s_barrier
    v_mfma_f32_32x32x16_bf16 v[36:51], v[140:143], v[132:135], v[36:51]
    ds_read_b64_tr_b16 v[68:69], v10 offset:28672
    ds_read_b64_tr_b16 v[70:71], v10 offset:29696
    ds_read_b128 v[72:75], v13 offset:28672
    v_mfma_f32_32x32x16_bf16 v[52:67], v[144:147], v[132:135], v[52:67]
    ds_read_b64_tr_b16 v[196:197], v16 offset:28672
    ds_read_b64_tr_b16 v[198:199], v16 offset:29696
    ds_read_b128 v[76:79], v13 offset:29696
    v_mfma_f32_16x16x32_bf16 v[228:231], v[212:215], v[212:215], v[228:231]
    v_mfma_f32_32x32x16_bf16 v[20:35], v[136:139], v[132:135], v[20:35]
    ds_read_b128 v[80:83], v13 offset:30720
    v_mfma_f32_16x16x32_bf16 v[236:239], v[252:255], v[212:215], v[236:239]
    v_mfma_f32_32x32x16_bf16 v[36:51], v[156:159], v[148:151], v[36:51]
    ds_read_b64_tr_b16 v[84:85], v10 offset:32768
    ds_read_b64_tr_b16 v[86:87], v10 offset:33792
    ds_read_b128 v[88:91], v13 offset:31744
    v_mfma_f32_32x32x16_bf16 v[52:67], v[160:163], v[148:151], v[52:67]
    ds_read_b64_tr_b16 v[200:201], v16 offset:28704
    ds_read_b64_tr_b16 v[202:203], v16 offset:29728
    ds_read_b128 v[92:95], v13 offset:32768
    v_mfma_f32_16x16x32_bf16 v[232:235], v[216:219], v[216:219], v[232:235]
    v_mfma_f32_32x32x16_bf16 v[20:35], v[152:155], v[148:151], v[20:35]
    ds_read_b128 v[96:99], v13 offset:33792
    v_mfma_f32_16x16x32_bf16 v[240:243], v[252:255], v[216:219], v[240:243]
    v_mfma_f32_32x32x16_bf16 v[36:51], v[172:175], v[164:167], v[36:51]
    ds_read_b64_tr_b16 v[100:101], v10 offset:36864
    ds_read_b64_tr_b16 v[102:103], v10 offset:37888
    ds_read_b128 v[104:107], v13 offset:34816
    v_mfma_f32_32x32x16_bf16 v[52:67], v[176:179], v[164:167], v[52:67]
    ds_read_b64_tr_b16 v[204:205], v16 offset:36864
    ds_read_b64_tr_b16 v[206:207], v16 offset:37888
    ds_read_b128 v[108:111], v13 offset:35840
    v_mfma_f32_16x16x32_bf16 v[228:231], v[220:223], v[220:223], v[228:231]
    v_mfma_f32_32x32x16_bf16 v[20:35], v[168:171], v[164:167], v[20:35]
    ds_read_b128 v[112:115], v13 offset:36864
    v_mfma_f32_16x16x32_bf16 v[236:239], v[252:255], v[220:223], v[236:239]
    v_mfma_f32_32x32x16_bf16 v[36:51], v[188:191], v[180:183], v[36:51]
    ds_read_b64_tr_b16 v[116:117], v10 offset:40960
    ds_read_b64_tr_b16 v[118:119], v10 offset:41984
    ds_read_b128 v[120:123], v13 offset:37888
    v_mfma_f32_32x32x16_bf16 v[52:67], v[192:195], v[180:183], v[52:67]
    ds_read_b64_tr_b16 v[208:209], v16 offset:36896
    ds_read_b64_tr_b16 v[210:211], v16 offset:37920
    ds_read_b128 v[124:127], v13 offset:38912
    v_mfma_f32_16x16x32_bf16 v[232:235], v[224:227], v[224:227], v[232:235]
    v_mfma_f32_32x32x16_bf16 v[20:35], v[184:187], v[180:183], v[20:35]
    ds_read_b128 v[128:131], v13 offset:39936
    v_mfma_f32_16x16x32_bf16 v[240:243], v[252:255], v[224:227], v[240:243]
    s_waitcnt lgkmcnt(0)
    s_barrier
    v_mfma_f32_32x32x16_bf16 v[36:51], v[76:79], v[68:71], v[36:51]
    ds_read_b64_tr_b16 v[132:133], v11 offset:0
    ds_read_b64_tr_b16 v[134:135], v11 offset:1024
    ds_read_b128 v[136:139], v14 offset:0
    v_mfma_f32_32x32x16_bf16 v[52:67], v[80:83], v[68:71], v[52:67]
    ds_read_b64_tr_b16 v[212:213], v17 offset:0
    ds_read_b64_tr_b16 v[214:215], v17 offset:1024
    ds_read_b128 v[140:143], v14 offset:1024
    v_mfma_f32_16x16x32_bf16 v[228:231], v[196:199], v[196:199], v[228:231]
    v_mfma_f32_32x32x16_bf16 v[20:35], v[72:75], v[68:71], v[20:35]
    ds_read_b128 v[144:147], v14 offset:2048
    v_mfma_f32_16x16x32_bf16 v[236:239], v[252:255], v[196:199], v[236:239]
    buffer_store_dwordx4 v[244:247], v3, s[20:23], s54 offen offset:0 sc1
    v_mfma_f32_32x32x16_bf16 v[36:51], v[92:95], v[84:87], v[36:51]
    ds_read_b64_tr_b16 v[148:149], v11 offset:4096
    ds_read_b64_tr_b16 v[150:151], v11 offset:5120
    ds_read_b128 v[152:155], v14 offset:3072
    v_mfma_f32_32x32x16_bf16 v[52:67], v[96:99], v[84:87], v[52:67]
    ds_read_b64_tr_b16 v[216:217], v17 offset:32
    ds_read_b64_tr_b16 v[218:219], v17 offset:1056
    ds_read_b128 v[156:159], v14 offset:4096
    v_mfma_f32_16x16x32_bf16 v[232:235], v[200:203], v[200:203], v[232:235]
    v_mfma_f32_32x32x16_bf16 v[20:35], v[88:91], v[84:87], v[20:35]
    ds_read_b128 v[160:163], v14 offset:5120
    v_mfma_f32_16x16x32_bf16 v[240:243], v[252:255], v[200:203], v[240:243]
    buffer_store_dwordx4 v[248:251], v3, s[20:23], s54 offen offset:1024 sc1
    v_mfma_f32_32x32x16_bf16 v[36:51], v[108:111], v[100:103], v[36:51]
    ds_read_b64_tr_b16 v[164:165], v11 offset:8192
    ds_read_b64_tr_b16 v[166:167], v11 offset:9216
    ds_read_b128 v[168:171], v14 offset:6144
    v_mfma_f32_32x32x16_bf16 v[52:67], v[112:115], v[100:103], v[52:67]
    ds_read_b64_tr_b16 v[220:221], v17 offset:8192
    ds_read_b64_tr_b16 v[222:223], v17 offset:9216
    ds_read_b128 v[172:175], v14 offset:7168
    v_mfma_f32_16x16x32_bf16 v[228:231], v[204:207], v[204:207], v[228:231]
    v_mfma_f32_32x32x16_bf16 v[20:35], v[104:107], v[100:103], v[20:35]
    ds_read_b128 v[176:179], v14 offset:8192
    v_mfma_f32_16x16x32_bf16 v[236:239], v[252:255], v[204:207], v[236:239]
    v_mfma_f32_32x32x16_bf16 v[36:51], v[124:127], v[116:119], v[36:51]
    ds_read_b64_tr_b16 v[180:181], v11 offset:12288
    ds_read_b64_tr_b16 v[182:183], v11 offset:13312
    ds_read_b128 v[184:187], v14 offset:9216
    v_mfma_f32_32x32x16_bf16 v[52:67], v[128:131], v[116:119], v[52:67]
    ds_read_b64_tr_b16 v[224:225], v17 offset:8224
    ds_read_b64_tr_b16 v[226:227], v17 offset:9248
    ds_read_b128 v[188:191], v14 offset:10240
    v_mfma_f32_16x16x32_bf16 v[232:235], v[208:211], v[208:211], v[232:235]
    v_mfma_f32_32x32x16_bf16 v[20:35], v[120:123], v[116:119], v[20:35]
    ds_read_b128 v[192:195], v14 offset:11264
    v_mfma_f32_16x16x32_bf16 v[240:243], v[252:255], v[208:211], v[240:243]
    s_waitcnt lgkmcnt(0)
    v_mfma_f32_32x32x16_bf16 v[36:51], v[140:143], v[132:135], v[36:51]
    v_mfma_f32_32x32x16_bf16 v[52:67], v[144:147], v[132:135], v[52:67]
    v_mfma_f32_16x16x32_bf16 v[228:231], v[212:215], v[212:215], v[228:231]
    v_mfma_f32_32x32x16_bf16 v[20:35], v[136:139], v[132:135], v[20:35]
    v_mfma_f32_16x16x32_bf16 v[236:239], v[252:255], v[212:215], v[236:239]
    v_mfma_f32_32x32x16_bf16 v[36:51], v[156:159], v[148:151], v[36:51]
    v_mfma_f32_32x32x16_bf16 v[52:67], v[160:163], v[148:151], v[52:67]
    v_mfma_f32_16x16x32_bf16 v[232:235], v[216:219], v[216:219], v[232:235]
    v_mfma_f32_32x32x16_bf16 v[20:35], v[152:155], v[148:151], v[20:35]
    v_mfma_f32_16x16x32_bf16 v[240:243], v[252:255], v[216:219], v[240:243]
    v_mfma_f32_32x32x16_bf16 v[36:51], v[172:175], v[164:167], v[36:51]
    v_mfma_f32_32x32x16_bf16 v[52:67], v[176:179], v[164:167], v[52:67]
    v_mfma_f32_16x16x32_bf16 v[228:231], v[220:223], v[220:223], v[228:231]
    v_mfma_f32_32x32x16_bf16 v[20:35], v[168:171], v[164:167], v[20:35]
    v_mfma_f32_16x16x32_bf16 v[236:239], v[252:255], v[220:223], v[236:239]
    v_mfma_f32_32x32x16_bf16 v[36:51], v[188:191], v[180:183], v[36:51]
    v_mfma_f32_32x32x16_bf16 v[52:67], v[192:195], v[180:183], v[52:67]
    v_mfma_f32_16x16x32_bf16 v[232:235], v[224:227], v[224:227], v[232:235]
    v_mfma_f32_32x32x16_bf16 v[20:35], v[184:187], v[180:183], v[20:35]
    v_mfma_f32_16x16x32_bf16 v[240:243], v[252:255], v[224:227], v[240:243]
    v_and_b32 v4, 3, v2
    v_cmp_eq_u32 s[60:61], 1, v4
    v_cmp_eq_u32 s[62:63], 2, v4
    v_cmp_eq_u32 vcc, 3, v4
    v_bfe_u32 v5, v2, 2, 2
    v_lshrrev_b32 v6, 4, v2
    v_cmp_eq_u32 s[58:59], v5, v6
    s_lshl_b32 s57, s41, 7
    s_add_u32 s57, s57, 86016
    v_and_b32 v5, 15, v2
    v_lshl_add_u32 v5, v5, 2, s57
    v_lshl_add_u32 v6, v8, 2, s57
    s_nop 3
    v_cndmask_b32 v228, v228, v229, s[60:61]
    v_cndmask_b32 v228, v228, v230, s[62:63]
    v_cndmask_b32 v228, v228, v231, vcc
    v_cndmask_b32 v232, v232, v233, s[60:61]
    v_cndmask_b32 v232, v232, v234, s[62:63]
    v_cndmask_b32 v232, v232, v235, vcc
    v_and_b32 v4, 16, v2
    v_cmp_eq_u32 vcc, 0, v4
    s_mov_b64 exec, s[58:59]
    ds_write_b32 v5, v228
    ds_write_b32 v5, v232 offset:64
    s_mov_b64 exec, -1
    v_cndmask_b32 v10, v240, v236, vcc
    ds_read_b32 v11, v6
    ds_read_b128 v[228:231], v9 offset:256
    ds_read_b128 v[232:235], v9 offset:272
    ds_read_b128 v[236:239], v9 offset:288
    ds_read_b128 v[240:243], v9 offset:304
    ds_read_b128 v[212:215], v9 offset:128
    ds_read_b128 v[216:219], v9 offset:144
    ds_read_b128 v[220:223], v9 offset:160
    ds_read_b128 v[224:227], v9 offset:176
    ds_read_b128 v[196:199], v9 offset:0
    ds_read_b128 v[200:203], v9 offset:16
    ds_read_b128 v[204:207], v9 offset:32
    ds_read_b128 v[208:211], v9 offset:48
    v_mov_b32 v18, 0x3f803f80
    s_waitcnt lgkmcnt(12)
    v_mul_f32 v10, 0x3b000000, v10
    v_mul_f32 v11, 0x3b000000, v11
    v_fma_f32 v11, -v10, v10, v11
    v_max_f32 v11, 0, v11
    v_add_f32 v11, 0x3727c5ac, v11
    v_rsq_f32 v12, v11
    s_mul_i32 s55, s41, 10752
    v_mul_u32_u24 v4, 336, v8
    v_lshl_add_u32 v4, v7, 6, v4
    v_add_u32 v4, s55, v4
    v_mul_f32 v14, 0x3fb8aa3b, v12
    s_waitcnt lgkmcnt(0)
    v_pk_fma_f32 v[52:53], v[228:229], v[10:11], v[52:53] op_sel_hi:[1,0,1] neg_lo:[0,1,0] neg_hi:[0,1,0]
    v_pk_fma_f32 v[54:55], v[230:231], v[10:11], v[54:55] op_sel_hi:[1,0,1] neg_lo:[0,1,0] neg_hi:[0,1,0]
    v_pk_fma_f32 v[56:57], v[232:233], v[10:11], v[56:57] op_sel_hi:[1,0,1] neg_lo:[0,1,0] neg_hi:[0,1,0]
    v_pk_fma_f32 v[58:59], v[234:235], v[10:11], v[58:59] op_sel_hi:[1,0,1] neg_lo:[0,1,0] neg_hi:[0,1,0]
    v_pk_fma_f32 v[60:61], v[236:237], v[10:11], v[60:61] op_sel_hi:[1,0,1] neg_lo:[0,1,0] neg_hi:[0,1,0]
    v_pk_fma_f32 v[62:63], v[238:239], v[10:11], v[62:63] op_sel_hi:[1,0,1] neg_lo:[0,1,0] neg_hi:[0,1,0]
    v_pk_fma_f32 v[64:65], v[240:241], v[10:11], v[64:65] op_sel_hi:[1,0,1] neg_lo:[0,1,0] neg_hi:[0,1,0]
    v_pk_fma_f32 v[66:67], v[242:243], v[10:11], v[66:67] op_sel_hi:[1,0,1] neg_lo:[0,1,0] neg_hi:[0,1,0]
    v_pk_mul_f32 v[52:53], v[52:53], v[12:13] op_sel_hi:[1,0]
    v_pk_mul_f32 v[54:55], v[54:55], v[12:13] op_sel_hi:[1,0]
    v_pk_mul_f32 v[56:57], v[56:57], v[12:13] op_sel_hi:[1,0]
    v_pk_mul_f32 v[58:59], v[58:59], v[12:13] op_sel_hi:[1,0]
    v_pk_mul_f32 v[60:61], v[60:61], v[12:13] op_sel_hi:[1,0]
    v_pk_mul_f32 v[62:63], v[62:63], v[12:13] op_sel_hi:[1,0]
    v_pk_mul_f32 v[64:65], v[64:65], v[12:13] op_sel_hi:[1,0]
    v_pk_mul_f32 v[66:67], v[66:67], v[12:13] op_sel_hi:[1,0]
    v_cvt_pk_bf16_f32 v128, v52, v53
    v_cvt_pk_bf16_f32 v129, v54, v55
    v_cvt_pk_bf16_f32 v130, v56, v57
    v_cvt_pk_bf16_f32 v131, v58, v59
    v_cvt_pk_bf16_f32 v132, v60, v61
    v_cvt_pk_bf16_f32 v133, v62, v63
    v_cvt_pk_bf16_f32 v134, v64, v65
    v_cvt_pk_bf16_f32 v135, v66, v67
    v_mov_b32 v136, v18
    v_mov_b32 v137, v18
    v_mov_b32 v138, v18
    v_mov_b32 v139, v18
    ds_write_b128 v4, v[128:131] offset:128
    ds_write_b128 v4, v[132:135] offset:144
    ds_write_b128 v4, v[136:139] offset:160
    ds_write_b128 v4, v[136:139] offset:176
    v_pk_fma_f32 v[36:37], v[212:213], v[10:11], v[36:37] op_sel_hi:[1,0,1] neg_lo:[0,1,0] neg_hi:[0,1,0]
    v_pk_fma_f32 v[38:39], v[214:215], v[10:11], v[38:39] op_sel_hi:[1,0,1] neg_lo:[0,1,0] neg_hi:[0,1,0]
    v_pk_fma_f32 v[40:41], v[216:217], v[10:11], v[40:41] op_sel_hi:[1,0,1] neg_lo:[0,1,0] neg_hi:[0,1,0]
    v_pk_fma_f32 v[42:43], v[218:219], v[10:11], v[42:43] op_sel_hi:[1,0,1] neg_lo:[0,1,0] neg_hi:[0,1,0]
    v_pk_fma_f32 v[44:45], v[220:221], v[10:11], v[44:45] op_sel_hi:[1,0,1] neg_lo:[0,1,0] neg_hi:[0,1,0]
    v_pk_fma_f32 v[46:47], v[222:223], v[10:11], v[46:47] op_sel_hi:[1,0,1] neg_lo:[0,1,0] neg_hi:[0,1,0]
    v_pk_fma_f32 v[48:49], v[224:225], v[10:11], v[48:49] op_sel_hi:[1,0,1] neg_lo:[0,1,0] neg_hi:[0,1,0]
    v_pk_fma_f32 v[50:51], v[226:227], v[10:11], v[50:51] op_sel_hi:[1,0,1] neg_lo:[0,1,0] neg_hi:[0,1,0]
    v_max3_f32 v100, v36, v37, v38
    v_min3_f32 v102, v36, v37, v38
    v_max3_f32 v100, v100, v39, v40
    v_min3_f32 v102, v102, v39, v40
    v_max3_f32 v100, v100, v41, v42
    v_min3_f32 v102, v102, v41, v42
    v_max3_f32 v100, v100, v43, v44
    v_min3_f32 v102, v102, v43, v44
    v_max3_f32 v100, v100, v45, v46
    v_min3_f32 v102, v102, v45, v46
    v_max3_f32 v100, v100, v47, v48
    v_min3_f32 v102, v102, v47, v48
    v_max3_f32 v100, v100, v49, v50
    v_min3_f32 v102, v102, v49, v50
    v_max_f32 v100, v100, v51
    v_min_f32 v102, v102, v51
    v_mul_f32 v100, v100, v14
    v_mul_f32 v102, v102, v14
    v_pk_fma_f32 v[68:69], v[36:37], v[14:15], v[100:101] op_sel_hi:[1,0,0] neg_lo:[0,0,1] neg_hi:[0,0,1]
    v_pk_fma_f32 v[84:85], v[36:37], v[14:15], v[102:103] op_sel_hi:[1,0,0] neg_lo:[1,0,0] neg_hi:[1,0,0]
    v_pk_fma_f32 v[70:71], v[38:39], v[14:15], v[100:101] op_sel_hi:[1,0,0] neg_lo:[0,0,1] neg_hi:[0,0,1]
    v_pk_fma_f32 v[86:87], v[38:39], v[14:15], v[102:103] op_sel_hi:[1,0,0] neg_lo:[1,0,0] neg_hi:[1,0,0]
    v_pk_fma_f32 v[72:73], v[40:41], v[14:15], v[100:101] op_sel_hi:[1,0,0] neg_lo:[0,0,1] neg_hi:[0,0,1]
    v_pk_fma_f32 v[88:89], v[40:41], v[14:15], v[102:103] op_sel_hi:[1,0,0] neg_lo:[1,0,0] neg_hi:[1,0,0]
    v_pk_fma_f32 v[74:75], v[42:43], v[14:15], v[100:101] op_sel_hi:[1,0,0] neg_lo:[0,0,1] neg_hi:[0,0,1]
    v_pk_fma_f32 v[90:91], v[42:43], v[14:15], v[102:103] op_sel_hi:[1,0,0] neg_lo:[1,0,0] neg_hi:[1,0,0]
    v_pk_fma_f32 v[76:77], v[44:45], v[14:15], v[100:101] op_sel_hi:[1,0,0] neg_lo:[0,0,1] neg_hi:[0,0,1]
    v_pk_fma_f32 v[92:93], v[44:45], v[14:15], v[102:103] op_sel_hi:[1,0,0] neg_lo:[1,0,0] neg_hi:[1,0,0]
    v_pk_fma_f32 v[78:79], v[46:47], v[14:15], v[100:101] op_sel_hi:[1,0,0] neg_lo:[0,0,1] neg_hi:[0,0,1]
    v_pk_fma_f32 v[94:95], v[46:47], v[14:15], v[102:103] op_sel_hi:[1,0,0] neg_lo:[1,0,0] neg_hi:[1,0,0]
    v_pk_fma_f32 v[80:81], v[48:49], v[14:15], v[100:101] op_sel_hi:[1,0,0] neg_lo:[0,0,1] neg_hi:[0,0,1]
    v_pk_fma_f32 v[96:97], v[48:49], v[14:15], v[102:103] op_sel_hi:[1,0,0] neg_lo:[1,0,0] neg_hi:[1,0,0]
    v_pk_fma_f32 v[82:83], v[50:51], v[14:15], v[100:101] op_sel_hi:[1,0,0] neg_lo:[0,0,1] neg_hi:[0,0,1]
    v_pk_fma_f32 v[98:99], v[50:51], v[14:15], v[102:103] op_sel_hi:[1,0,0] neg_lo:[1,0,0] neg_hi:[1,0,0]
    v_exp_f32 v68, v68
    v_exp_f32 v69, v69
    v_exp_f32 v70, v70
    v_exp_f32 v71, v71
    v_exp_f32 v72, v72
    v_exp_f32 v73, v73
    v_exp_f32 v74, v74
    v_exp_f32 v75, v75
    v_exp_f32 v76, v76
    v_exp_f32 v77, v77
    v_exp_f32 v78, v78
    v_exp_f32 v79, v79
    v_exp_f32 v80, v80
    v_exp_f32 v81, v81
    v_exp_f32 v82, v82
    v_exp_f32 v83, v83
    v_exp_f32 v84, v84
    v_exp_f32 v85, v85
    v_exp_f32 v86, v86
    v_exp_f32 v87, v87
    v_exp_f32 v88, v88
    v_exp_f32 v89, v89
    v_exp_f32 v90, v90
    v_exp_f32 v91, v91
    v_exp_f32 v92, v92
    v_exp_f32 v93, v93
    v_exp_f32 v94, v94
    v_exp_f32 v95, v95
    v_exp_f32 v96, v96
    v_exp_f32 v97, v97
    v_exp_f32 v98, v98
    v_exp_f32 v99, v99
    v_pk_add_f32 v[100:101], v[68:69], v[70:71]
    v_pk_add_f32 v[102:103], v[84:85], v[86:87]
    v_pk_add_f32 v[100:101], v[100:101], v[72:73]
    v_pk_add_f32 v[102:103], v[102:103], v[88:89]
    v_pk_add_f32 v[100:101], v[100:101], v[74:75]
    v_pk_add_f32 v[102:103], v[102:103], v[90:91]
    v_pk_add_f32 v[100:101], v[100:101], v[76:77]
    v_pk_add_f32 v[102:103], v[102:103], v[92:93]
    v_pk_add_f32 v[100:101], v[100:101], v[78:79]
    v_pk_add_f32 v[102:103], v[102:103], v[94:95]
    v_pk_add_f32 v[100:101], v[100:101], v[80:81]
    v_pk_add_f32 v[102:103], v[102:103], v[96:97]
    v_pk_add_f32 v[100:101], v[100:101], v[82:83]
    v_pk_add_f32 v[102:103], v[102:103], v[98:99]
    v_add_f32 v100, v100, v101
    v_add_f32 v102, v102, v103
    v_rcp_f32 v100, v100
    v_rcp_f32 v102, v102
    s_nop 0
    v_pk_mul_f32 v[68:69], v[68:69], v[100:101] op_sel_hi:[1,0]
    v_pk_mul_f32 v[84:85], v[84:85], v[102:103] op_sel_hi:[1,0]
    v_pk_mul_f32 v[70:71], v[70:71], v[100:101] op_sel_hi:[1,0]
    v_pk_mul_f32 v[86:87], v[86:87], v[102:103] op_sel_hi:[1,0]
    v_pk_mul_f32 v[72:73], v[72:73], v[100:101] op_sel_hi:[1,0]
    v_pk_mul_f32 v[88:89], v[88:89], v[102:103] op_sel_hi:[1,0]
    v_pk_mul_f32 v[74:75], v[74:75], v[100:101] op_sel_hi:[1,0]
    v_pk_mul_f32 v[90:91], v[90:91], v[102:103] op_sel_hi:[1,0]
    v_pk_mul_f32 v[76:77], v[76:77], v[100:101] op_sel_hi:[1,0]
    v_pk_mul_f32 v[92:93], v[92:93], v[102:103] op_sel_hi:[1,0]
    v_pk_mul_f32 v[78:79], v[78:79], v[100:101] op_sel_hi:[1,0]
    v_pk_mul_f32 v[94:95], v[94:95], v[102:103] op_sel_hi:[1,0]
    v_pk_mul_f32 v[80:81], v[80:81], v[100:101] op_sel_hi:[1,0]
    v_pk_mul_f32 v[96:97], v[96:97], v[102:103] op_sel_hi:[1,0]
    v_pk_mul_f32 v[82:83], v[82:83], v[100:101] op_sel_hi:[1,0]
    v_pk_mul_f32 v[98:99], v[98:99], v[102:103] op_sel_hi:[1,0]
    v_cvt_pk_bf16_f32 v112, v68, v69
    v_cvt_pk_bf16_f32 v113, v70, v71
    v_cvt_pk_bf16_f32 v114, v72, v73
    v_cvt_pk_bf16_f32 v115, v74, v75
    v_cvt_pk_bf16_f32 v116, v76, v77
    v_cvt_pk_bf16_f32 v117, v78, v79
    v_cvt_pk_bf16_f32 v118, v80, v81
    v_cvt_pk_bf16_f32 v119, v82, v83
    v_cvt_pk_bf16_f32 v120, v84, v85
    v_cvt_pk_bf16_f32 v121, v86, v87
    v_cvt_pk_bf16_f32 v122, v88, v89
    v_cvt_pk_bf16_f32 v123, v90, v91
    v_cvt_pk_bf16_f32 v124, v92, v93
    v_cvt_pk_bf16_f32 v125, v94, v95
    v_cvt_pk_bf16_f32 v126, v96, v97
    v_cvt_pk_bf16_f32 v127, v98, v99
    ds_write_b128 v4, v[112:115] offset:0
    ds_write_b128 v4, v[116:119] offset:16
    ds_write_b128 v4, v[120:123] offset:32
    ds_write_b128 v4, v[124:127] offset:48
    s_waitcnt lgkmcnt(0)
    s_barrier
    v_pk_fma_f32 v[20:21], v[196:197], v[10:11], v[20:21] op_sel_hi:[1,0,1] neg_lo:[0,1,0] neg_hi:[0,1,0]
    v_pk_fma_f32 v[22:23], v[198:199], v[10:11], v[22:23] op_sel_hi:[1,0,1] neg_lo:[0,1,0] neg_hi:[0,1,0]
    v_pk_fma_f32 v[24:25], v[200:201], v[10:11], v[24:25] op_sel_hi:[1,0,1] neg_lo:[0,1,0] neg_hi:[0,1,0]
    v_pk_fma_f32 v[26:27], v[202:203], v[10:11], v[26:27] op_sel_hi:[1,0,1] neg_lo:[0,1,0] neg_hi:[0,1,0]
    v_pk_fma_f32 v[28:29], v[204:205], v[10:11], v[28:29] op_sel_hi:[1,0,1] neg_lo:[0,1,0] neg_hi:[0,1,0]
    v_pk_fma_f32 v[30:31], v[206:207], v[10:11], v[30:31] op_sel_hi:[1,0,1] neg_lo:[0,1,0] neg_hi:[0,1,0]
    v_pk_fma_f32 v[32:33], v[208:209], v[10:11], v[32:33] op_sel_hi:[1,0,1] neg_lo:[0,1,0] neg_hi:[0,1,0]
    v_pk_fma_f32 v[34:35], v[210:211], v[10:11], v[34:35] op_sel_hi:[1,0,1] neg_lo:[0,1,0] neg_hi:[0,1,0]
    v_max3_f32 v100, v20, v21, v22
    v_min3_f32 v102, v20, v21, v22
    v_max3_f32 v100, v100, v23, v24
    v_min3_f32 v102, v102, v23, v24
    v_max3_f32 v100, v100, v25, v26
    v_min3_f32 v102, v102, v25, v26
    v_max3_f32 v100, v100, v27, v28
    v_min3_f32 v102, v102, v27, v28
    v_max3_f32 v100, v100, v29, v30
    v_min3_f32 v102, v102, v29, v30
    v_max3_f32 v100, v100, v31, v32
    v_min3_f32 v102, v102, v31, v32
    v_max3_f32 v100, v100, v33, v34
    v_min3_f32 v102, v102, v33, v34
    v_max_f32 v100, v100, v35
    v_min_f32 v102, v102, v35
    v_mul_f32 v100, v100, v14
    v_mul_f32 v102, v102, v14
    v_pk_fma_f32 v[68:69], v[20:21], v[14:15], v[100:101] op_sel_hi:[1,0,0] neg_lo:[0,0,1] neg_hi:[0,0,1]
    v_pk_fma_f32 v[84:85], v[20:21], v[14:15], v[102:103] op_sel_hi:[1,0,0] neg_lo:[1,0,0] neg_hi:[1,0,0]
    v_pk_fma_f32 v[70:71], v[22:23], v[14:15], v[100:101] op_sel_hi:[1,0,0] neg_lo:[0,0,1] neg_hi:[0,0,1]
    v_pk_fma_f32 v[86:87], v[22:23], v[14:15], v[102:103] op_sel_hi:[1,0,0] neg_lo:[1,0,0] neg_hi:[1,0,0]
    v_pk_fma_f32 v[72:73], v[24:25], v[14:15], v[100:101] op_sel_hi:[1,0,0] neg_lo:[0,0,1] neg_hi:[0,0,1]
    v_pk_fma_f32 v[88:89], v[24:25], v[14:15], v[102:103] op_sel_hi:[1,0,0] neg_lo:[1,0,0] neg_hi:[1,0,0]
    v_pk_fma_f32 v[74:75], v[26:27], v[14:15], v[100:101] op_sel_hi:[1,0,0] neg_lo:[0,0,1] neg_hi:[0,0,1]
    v_pk_fma_f32 v[90:91], v[26:27], v[14:15], v[102:103] op_sel_hi:[1,0,0] neg_lo:[1,0,0] neg_hi:[1,0,0]
    v_pk_fma_f32 v[76:77], v[28:29], v[14:15], v[100:101] op_sel_hi:[1,0,0] neg_lo:[0,0,1] neg_hi:[0,0,1]
    v_pk_fma_f32 v[92:93], v[28:29], v[14:15], v[102:103] op_sel_hi:[1,0,0] neg_lo:[1,0,0] neg_hi:[1,0,0]
    v_pk_fma_f32 v[78:79], v[30:31], v[14:15], v[100:101] op_sel_hi:[1,0,0] neg_lo:[0,0,1] neg_hi:[0,0,1]
    v_pk_fma_f32 v[94:95], v[30:31], v[14:15], v[102:103] op_sel_hi:[1,0,0] neg_lo:[1,0,0] neg_hi:[1,0,0]
    v_pk_fma_f32 v[80:81], v[32:33], v[14:15], v[100:101] op_sel_hi:[1,0,0] neg_lo:[0,0,1] neg_hi:[0,0,1]
    v_pk_fma_f32 v[96:97], v[32:33], v[14:15], v[102:103] op_sel_hi:[1,0,0] neg_lo:[1,0,0] neg_hi:[1,0,0]
    v_pk_fma_f32 v[82:83], v[34:35], v[14:15], v[100:101] op_sel_hi:[1,0,0] neg_lo:[0,0,1] neg_hi:[0,0,1]
    v_pk_fma_f32 v[98:99], v[34:35], v[14:15], v[102:103] op_sel_hi:[1,0,0] neg_lo:[1,0,0] neg_hi:[1,0,0]
    v_exp_f32 v68, v68
    v_exp_f32 v69, v69
    v_exp_f32 v70, v70
    v_exp_f32 v71, v71
    v_exp_f32 v72, v72
    v_exp_f32 v73, v73
    v_exp_f32 v74, v74
    v_exp_f32 v75, v75
    v_exp_f32 v76, v76
    v_exp_f32 v77, v77
    v_exp_f32 v78, v78
    v_exp_f32 v79, v79
    v_exp_f32 v80, v80
    v_exp_f32 v81, v81
    v_exp_f32 v82, v82
    v_exp_f32 v83, v83
    v_exp_f32 v84, v84
    v_exp_f32 v85, v85
    v_exp_f32 v86, v86
    v_exp_f32 v87, v87
    v_exp_f32 v88, v88
    v_exp_f32 v89, v89
    v_exp_f32 v90, v90
    v_exp_f32 v91, v91
    v_exp_f32 v92, v92
    v_exp_f32 v93, v93
    v_exp_f32 v94, v94
    v_exp_f32 v95, v95
    v_exp_f32 v96, v96
    v_exp_f32 v97, v97
    v_exp_f32 v98, v98
    v_exp_f32 v99, v99
    v_pk_add_f32 v[100:101], v[68:69], v[70:71]
    v_pk_add_f32 v[102:103], v[84:85], v[86:87]
    v_pk_add_f32 v[100:101], v[100:101], v[72:73]
    v_pk_add_f32 v[102:103], v[102:103], v[88:89]
    v_pk_add_f32 v[100:101], v[100:101], v[74:75]
    v_pk_add_f32 v[102:103], v[102:103], v[90:91]
    v_pk_add_f32 v[100:101], v[100:101], v[76:77]
    v_pk_add_f32 v[102:103], v[102:103], v[92:93]
    v_pk_add_f32 v[100:101], v[100:101], v[78:79]
    v_pk_add_f32 v[102:103], v[102:103], v[94:95]
    v_pk_add_f32 v[100:101], v[100:101], v[80:81]
    v_pk_add_f32 v[102:103], v[102:103], v[96:97]
    v_pk_add_f32 v[100:101], v[100:101], v[82:83]
    v_pk_add_f32 v[102:103], v[102:103], v[98:99]
    v_add_f32 v100, v100, v101
    v_add_f32 v102, v102, v103
    v_rcp_f32 v100, v100
    v_rcp_f32 v102, v102
    s_nop 0
    v_pk_mul_f32 v[68:69], v[68:69], v[100:101] op_sel_hi:[1,0]
    v_pk_mul_f32 v[84:85], v[84:85], v[102:103] op_sel_hi:[1,0]
    v_pk_mul_f32 v[70:71], v[70:71], v[100:101] op_sel_hi:[1,0]
    v_pk_mul_f32 v[86:87], v[86:87], v[102:103] op_sel_hi:[1,0]
    v_pk_mul_f32 v[72:73], v[72:73], v[100:101] op_sel_hi:[1,0]
    v_pk_mul_f32 v[88:89], v[88:89], v[102:103] op_sel_hi:[1,0]
    v_pk_mul_f32 v[74:75], v[74:75], v[100:101] op_sel_hi:[1,0]
    v_pk_mul_f32 v[90:91], v[90:91], v[102:103] op_sel_hi:[1,0]
    v_pk_mul_f32 v[76:77], v[76:77], v[100:101] op_sel_hi:[1,0]
    v_pk_mul_f32 v[92:93], v[92:93], v[102:103] op_sel_hi:[1,0]
    v_pk_mul_f32 v[78:79], v[78:79], v[100:101] op_sel_hi:[1,0]
    v_pk_mul_f32 v[94:95], v[94:95], v[102:103] op_sel_hi:[1,0]
    v_pk_mul_f32 v[80:81], v[80:81], v[100:101] op_sel_hi:[1,0]
    v_pk_mul_f32 v[96:97], v[96:97], v[102:103] op_sel_hi:[1,0]
    v_pk_mul_f32 v[82:83], v[82:83], v[100:101] op_sel_hi:[1,0]
    v_pk_mul_f32 v[98:99], v[98:99], v[102:103] op_sel_hi:[1,0]
    v_cvt_pk_bf16_f32 v112, v68, v69
    v_cvt_pk_bf16_f32 v113, v70, v71
    v_cvt_pk_bf16_f32 v114, v72, v73
    v_cvt_pk_bf16_f32 v115, v74, v75
    v_cvt_pk_bf16_f32 v116, v76, v77
    v_cvt_pk_bf16_f32 v117, v78, v79
    v_cvt_pk_bf16_f32 v118, v80, v81
    v_cvt_pk_bf16_f32 v119, v82, v83
    v_cvt_pk_bf16_f32 v120, v84, v85
    v_cvt_pk_bf16_f32 v121, v86, v87
    v_cvt_pk_bf16_f32 v122, v88, v89
    v_cvt_pk_bf16_f32 v123, v90, v91
    v_cvt_pk_bf16_f32 v124, v92, v93
    v_cvt_pk_bf16_f32 v125, v94, v95
    v_cvt_pk_bf16_f32 v126, v96, v97
    v_cvt_pk_bf16_f32 v127, v98, v99
    v_lshlrev_b32 v5, 4, v8
    v_lshl_add_u32 v5, v7, 11, v5
    s_lshl_b32 s55, s44, 2
    s_add_u32 s55, s55, s41
    s_lshl_b32 s55, s55, 16
    s_lshl_b32 s56, s45, 12
    s_add_u32 s55, s55, s56
    s_add_u32 s55, s55, 20971520
    buffer_store_dwordx4 v[112:115], v5, s[20:23], s55 offen offset:0 sc1
    buffer_store_dwordx4 v[116:119], v5, s[20:23], s55 offen offset:512 sc1
    buffer_store_dwordx4 v[120:123], v5, s[20:23], s55 offen offset:1024 sc1
    buffer_store_dwordx4 v[124:127], v5, s[20:23], s55 offen offset:1536 sc1
K5_DONE:
    s_endpgm
.globl proj2_kernel
.p2align 8
.type proj2_kernel,@function
proj2_kernel:
    s_cmp_ge_u32 s2, 256
    s_cbranch_scc1 K6_DONE
    s_load_dwordx2 s[18:19], s[0:1], 96
    s_load_dwordx2 s[16:17], s[0:1], 80
    v_lshrrev_b32 v1, 6, v0
    v_and_b32 v2, 63, v0
    v_readfirstlane_b32 s41, v1
    s_and_b32 s42, s2, 7
    s_lshr_b32 s43, s2, 3
    s_lshl_b32 s44, s42, 3
    s_lshr_b32 s45, s43, 2
    s_add_u32 s44, s44, s45
    s_and_b32 s45, s43, 3
    v_lshlrev_b32 v3, 4, v2
    v_lshrrev_b32 v7, 5, v2
    v_and_b32 v8, 31, v2
    v_bfe_u32 v4, v8, 2, 1
    v_bfe_u32 v5, v8, 3, 1
    v_and_b32 v6, 3, v8
    v_lshl_add_u32 v6, v5, 2, v6
    v_lshl_add_u32 v6, v4, 3, v6
    v_cmp_gt_u32 vcc, 16, v8
    v_lshlrev_b32 v9, 10, v8
    v_lshl_add_u32 v9, v7, 5, v9
    v_cndmask_b32 v6, 16, v6, vcc
    v_and_b32 v4, 7, v6
    v_lshlrev_b32 v6, 7, v6
    v_lshlrev_b32 v5, 5, v7
    s_mul_i32 s56, s41, 17408
    s_add_u32 s56, s56, 43008
    v_add_u32 v6, s56, v6
    v_lshrrev_b32 v60, 3, v2
    v_xor_b32 v60, v60, v2
    v_and_b32 v60, 7, v60
    v_and_b32 v61, 56, v2
    v_or_b32 v60, v60, v61
    v_lshlrev_b32 v63, 4, v60
    s_lshl_b32 s46, s44, 16
    s_lshl_b32 s47, s41, 14
    s_add_u32 s46, s46, s47
    s_add_u32 s46, s46, 20971520
    s_mul_i32 s47, s41, 17408
    s_add_u32 s47, s47, 25296896
    s_lshl_b32 s48, s45, 2
    s_add_u32 s48, s48, s41
    s_lshl_b32 s49, s48, 6
    s_lshl_b32 s48, s48, 15
    s_add_u32 s48, s48, 8388608
    s_lshl_b32 s50, s44, 15
    s_add_u32 s49, s49, s50
    s_lshl_b32 s51, s45, 13
    s_add_u32 s50, s50, s51
    s_lshl_b32 s51, s41, 11
    s_add_u32 s50, s50, s51
    s_add_u32 s50, s50, 17825792
    v_lshlrev_b32 v11, 5, v2
    s_lshl_b32 s51, s41, 13
    v_add_u32 v10, s51, v3
    s_waitcnt lgkmcnt(0)
    s_mov_b32 s20, s18
    s_mov_b32 s21, s19
    s_mov_b32 s22, 33554432
    s_mov_b32 s23, 0x20000
    s_mov_b32 s24, s16
    s_mov_b32 s25, s17
    s_mov_b32 s26, 2097152
    s_mov_b32 s27, 0x20000
    s_mov_b32 m0, s56
    s_nop 0
    buffer_load_dwordx4 v63, s[20:23], s47 offen offset:0 lds
    buffer_load_dwordx4 v63, s[20:23], s47 offen offset:1024 lds
    buffer_load_dwordx4 v63, s[20:23], s47 offen offset:2048 lds
    buffer_load_dwordx4 v[64:67], v3, s[20:23], s46 offen offset:0
    buffer_load_dwordx4 v[68:71], v3, s[20:23], s46 offen offset:1024
    buffer_load_dwordx4 v63, s[20:23], s47 offen offset:3072 lds
    s_add_u32 s47, s47, 4096
    s_add_u32 m0, m0, 4096
    s_nop 0
    buffer_load_dwordx4 v63, s[20:23], s47 offen offset:0 lds
    buffer_load_dwordx4 v[72:75], v3, s[20:23], s46 offen offset:2048
    buffer_load_dwordx4 v[76:79], v3, s[20:23], s46 offen offset:3072
    buffer_load_dwordx4 v63, s[20:23], s47 offen offset:1024 lds
    buffer_load_dwordx4 v63, s[20:23], s47 offen offset:2048 lds
    s_add_u32 s46, s46, 4096
    buffer_load_dwordx4 v[80:83], v3, s[20:23], s46 offen offset:0
    buffer_load_dwordx4 v[84:87], v3, s[20:23], s46 offen offset:1024
    buffer_load_dwordx4 v63, s[20:23], s47 offen offset:3072 lds
    s_add_u32 s47, s47, 4096
    s_add_u32 m0, m0, 4096
    s_nop 0
    buffer_load_dwordx4 v63, s[20:23], s47 offen offset:0 lds
    buffer_load_dwordx4 v[88:91], v3, s[20:23], s46 offen offset:2048
    buffer_load_dwordx4 v[92:95], v3, s[20:23], s46 offen offset:3072
    buffer_load_dwordx4 v63, s[20:23], s47 offen offset:1024 lds
    buffer_load_dwordx4 v63, s[20:23], s47 offen offset:2048 lds
    s_add_u32 s46, s46, 4096
    buffer_load_dwordx4 v[96:99], v3, s[20:23], s46 offen offset:0
    buffer_load_dwordx4 v[100:103], v3, s[20:23], s46 offen offset:1024
    buffer_load_dwordx4 v63, s[20:23], s47 offen offset:3072 lds
    s_add_u32 s47, s47, 4096
    s_add_u32 m0, m0, 4096
    s_nop 0
    buffer_load_dwordx4 v63, s[20:23], s47 offen offset:0 lds
    buffer_load_dwordx4 v[104:107], v3, s[20:23], s46 offen offset:2048
    buffer_load_dwordx4 v[108:111], v3, s[20:23], s46 offen offset:3072
    buffer_load_dwordx4 v63, s[20:23], s47 offen offset:1024 lds
    buffer_load_dwordx4 v63, s[20:23], s47 offen offset:2048 lds
    s_add_u32 s46, s46, 4096
    buffer_load_dwordx4 v[112:115], v3, s[20:23], s46 offen offset:0
    buffer_load_dwordx4 v[116:119], v3, s[20:23], s46 offen offset:1024
    buffer_load_dwordx4 v63, s[20:23], s47 offen offset:3072 lds
    s_add_u32 s47, s47, 4096
    s_add_u32 m0, m0, 4096
    s_nop 0
    buffer_load_dwordx4 v63, s[20:23], s47 offen offset:0 lds
    buffer_load_dwordx4 v[120:123], v3, s[20:23], s46 offen offset:2048
    buffer_load_dwordx4 v[124:127], v3, s[20:23], s46 offen offset:3072
    buffer_load_dwordx4 v[52:55], v11, s[20:23], s50 offen
    buffer_load_dwordx4 v[56:59], v11, s[20:23], s50 offen offset:16
    v_add_u32 v1, 0, v4
    v_and_b32 v1, 7, v1
    v_lshlrev_b32 v1, 4, v1
    v_xor_b32 v1, v1, v5
    v_add_u32 v1, v1, v6
    v_xor_b32 v60, 16, v1
    v_xor_b32 v61, 64, v1
    v_xor_b32 v62, 80, v1
    s_waitcnt vmcnt(30)
    ds_read_b128 v[240:243], v1 offset:0
    ds_read_b128 v[244:247], v60 offset:0
    ds_read_b128 v[248:251], v61 offset:0
    ds_read_b128 v[252:255], v62 offset:0
    s_waitcnt lgkmcnt(0)
    v_cvt_pk_bf16_f32 v12, v240, v241
    v_cvt_pk_bf16_f32 v13, v242, v243
    v_cvt_pk_bf16_f32 v14, v244, v245
    v_cvt_pk_bf16_f32 v15, v246, v247
    v_cvt_pk_bf16_f32 v16, v248, v249
    v_cvt_pk_bf16_f32 v17, v250, v251
    v_cvt_pk_bf16_f32 v18, v252, v253
    v_cvt_pk_bf16_f32 v19, v254, v255
    s_nop 1
    v_mfma_f32_32x32x16_bf16 v[20:35], v[12:15], v[64:67], 0
    v_mfma_f32_32x32x16_bf16 v[20:35], v[16:19], v[68:71], v[20:35]
    buffer_load_dwordx4 v[128:131], v3, s[20:23], s48 offen offset:0
    buffer_load_dwordx4 v[132:135], v3, s[20:23], s48 offen offset:1024
    buffer_load_dwordx4 v[136:139], v3, s[20:23], s48 offen offset:2048
    buffer_load_dwordx4 v[140:143], v3, s[20:23], s48 offen offset:3072
    v_add_u32 v1, 1, v4
    v_and_b32 v1, 7, v1
    v_lshlrev_b32 v1, 4, v1
    v_xor_b32 v1, v1, v5
    v_add_u32 v1, v1, v6
    v_xor_b32 v60, 16, v1
    v_xor_b32 v61, 64, v1
    v_xor_b32 v62, 80, v1
    s_waitcnt vmcnt(30)
    ds_read_b128 v[240:243], v1 offset:2176
    ds_read_b128 v[244:247], v60 offset:2176
    ds_read_b128 v[248:251], v61 offset:2176
    ds_read_b128 v[252:255], v62 offset:2176
    s_nop 3
    s_waitcnt lgkmcnt(0)
    v_cvt_pk_bf16_f32 v12, v240, v241
    v_cvt_pk_bf16_f32 v13, v242, v243
    v_cvt_pk_bf16_f32 v14, v244, v245
    v_cvt_pk_bf16_f32 v15, v246, v247
    v_cvt_pk_bf16_f32 v16, v248, v249
    v_cvt_pk_bf16_f32 v17, v250, v251
    v_cvt_pk_bf16_f32 v18, v252, v253
    v_cvt_pk_bf16_f32 v19, v254, v255
    s_nop 1
    v_mfma_f32_32x32x16_bf16 v[36:51], v[12:15], v[72:75], 0
    v_mfma_f32_32x32x16_bf16 v[36:51], v[16:19], v[76:79], v[36:51]
    s_add_u32 s48, s48, 4096
    buffer_load_dwordx4 v[144:147], v3, s[20:23], s48 offen offset:0
    buffer_load_dwordx4 v[148:151], v3, s[20:23], s48 offen offset:1024
    buffer_load_dwordx4 v[152:155], v3, s[20:23], s48 offen offset:2048
    buffer_load_dwordx4 v[156:159], v3, s[20:23], s48 offen offset:3072
    v_add_u32 v1, 2, v4
    v_and_b32 v1, 7, v1
    v_lshlrev_b32 v1, 4, v1
    v_xor_b32 v1, v1, v5
    v_add_u32 v1, v1, v6
    v_xor_b32 v60, 16, v1
    v_xor_b32 v61, 64, v1
    v_xor_b32 v62, 80, v1
    s_waitcnt vmcnt(30)
    ds_read_b128 v[240:243], v1 offset:4352
    ds_read_b128 v[244:247], v60 offset:4352
    ds_read_b128 v[248:251], v61 offset:4352
    ds_read_b128 v[252:255], v62 offset:4352
    v_add_f32 v11, 0x358637bd, v28
    v_rcp_f32 v11, v11
    s_nop 0
    v_mul_f32 v20, v20, v11
    v_mul_f32 v21, v21, v11
    v_mul_f32 v22, v22, v11
    v_mul_f32 v23, v23, v11
    v_mul_f32 v24, v24, v11
    v_mul_f32 v25, v25, v11
    v_mul_f32 v26, v26, v11
    v_mul_f32 v27, v27, v11
    v_cvt_pk_bf16_f32 v28, v20, v21
    v_cvt_pk_bf16_f32 v29, v22, v23
    v_cvt_pk_bf16_f32 v30, v24, v25
    v_cvt_pk_bf16_f32 v31, v26, v27
    ds_write_b128 v10, v[28:31] offset:0
    s_waitcnt lgkmcnt(1)
    v_cvt_pk_bf16_f32 v12, v240, v241
    v_cvt_pk_bf16_f32 v13, v242, v243
    v_cvt_pk_bf16_f32 v14, v244, v245
    v_cvt_pk_bf16_f32 v15, v246, v247
    v_cvt_pk_bf16_f32 v16, v248, v249
    v_cvt_pk_bf16_f32 v17, v250, v251
    v_cvt_pk_bf16_f32 v18, v252, v253
    v_cvt_pk_bf16_f32 v19, v254, v255
    s_nop 1
    v_mfma_f32_32x32x16_bf16 v[20:35], v[12:15], v[80:83], 0
    v_mfma_f32_32x32x16_bf16 v[20:35], v[16:19], v[84:87], v[20:35]
    s_add_u32 s48, s48, 4096
    buffer_load_dwordx4 v[160:163], v3, s[20:23], s48 offen offset:0
    buffer_load_dwordx4 v[164:167], v3, s[20:23], s48 offen offset:1024
    buffer_load_dwordx4 v[168:171], v3, s[20:23], s48 offen offset:2048
    buffer_load_dwordx4 v[172:175], v3, s[20:23], s48 offen offset:3072
    v_add_u32 v1, 3, v4
    v_and_b32 v1, 7, v1
    v_lshlrev_b32 v1, 4, v1
    v_xor_b32 v1, v1, v5
    v_add_u32 v1, v1, v6
    v_xor_b32 v60, 16, v1
    v_xor_b32 v61, 64, v1
    v_xor_b32 v62, 80, v1
    s_waitcnt vmcnt(30)
    ds_read_b128 v[240:243], v1 offset:6528
    ds_read_b128 v[244:247], v60 offset:6528
    ds_read_b128 v[248:251], v61 offset:6528
    ds_read_b128 v[252:255], v62 offset:6528
    v_add_f32 v11, 0x358637bd, v44
    v_rcp_f32 v11, v11
    s_nop 0
    v_mul_f32 v36, v36, v11
    v_mul_f32 v37, v37, v11
    v_mul_f32 v38, v38, v11
    v_mul_f32 v39, v39, v11
    v_mul_f32 v40, v40, v11
    v_mul_f32 v41, v41, v11
    v_mul_f32 v42, v42, v11
    v_mul_f32 v43, v43, v11
    v_cvt_pk_bf16_f32 v44, v36, v37
    v_cvt_pk_bf16_f32 v45, v38, v39
    v_cvt_pk_bf16_f32 v46, v40, v41
    v_cvt_pk_bf16_f32 v47, v42, v43
    ds_write_b128 v10, v[44:47] offset:1024
    s_waitcnt lgkmcnt(1)
    v_cvt_pk_bf16_f32 v12, v240, v241
    v_cvt_pk_bf16_f32 v13, v242, v243
    v_cvt_pk_bf16_f32 v14, v244, v245
    v_cvt_pk_bf16_f32 v15, v246, v247
    v_cvt_pk_bf16_f32 v16, v248, v249
    v_cvt_pk_bf16_f32 v17, v250, v251
    v_cvt_pk_bf16_f32 v18, v252, v253
    v_cvt_pk_bf16_f32 v19, v254, v255
    s_nop 1
    v_mfma_f32_32x32x16_bf16 v[36:51], v[12:15], v[88:91], 0
    v_mfma_f32_32x32x16_bf16 v[36:51], v[16:19], v[92:95], v[36:51]
    s_add_u32 s48, s48, 4096
    buffer_load_dwordx4 v[176:179], v3, s[20:23], s48 offen offset:0
    buffer_load_dwordx4 v[180:183], v3, s[20:23], s48 offen offset:1024
    buffer_load_dwordx4 v[184:187], v3, s[20:23], s48 offen offset:2048
    buffer_load_dwordx4 v[188:191], v3, s[20:23], s48 offen offset:3072
    v_add_u32 v1, 4, v4
    v_and_b32 v1, 7, v1
    v_lshlrev_b32 v1, 4, v1
    v_xor_b32 v1, v1, v5
    v_add_u32 v1, v1, v6
    v_xor_b32 v60, 16, v1
    v_xor_b32 v61, 64, v1
    v_xor_b32 v62, 80, v1
    s_waitcnt vmcnt(30)
    ds_read_b128 v[240:243], v1 offset:8704
    ds_read_b128 v[244:247], v60 offset:8704
    ds_read_b128 v[248:251], v61 offset:8704
    ds_read_b128 v[252:255], v62 offset:8704
    v_add_f32 v11, 0x358637bd, v28
    v_rcp_f32 v11, v11
    s_nop 0
    v_mul_f32 v20, v20, v11
    v_mul_f32 v21, v21, v11
    v_mul_f32 v22, v22, v11
    v_mul_f32 v23, v23, v11
    v_mul_f32 v24, v24, v11
    v_mul_f32 v25, v25, v11
    v_mul_f32 v26, v26, v11
    v_mul_f32 v27, v27, v11
    v_cvt_pk_bf16_f32 v28, v20, v21
    v_cvt_pk_bf16_f32 v29, v22, v23
    v_cvt_pk_bf16_f32 v30, v24, v25
    v_cvt_pk_bf16_f32 v31, v26, v27
    ds_write_b128 v10, v[28:31] offset:2048
    s_waitcnt lgkmcnt(1)
    v_cvt_pk_bf16_f32 v12, v240, v241
    v_cvt_pk_bf16_f32 v13, v242, v243
    v_cvt_pk_bf16_f32 v14, v244, v245
    v_cvt_pk_bf16_f32 v15, v246, v247
    v_cvt_pk_bf16_f32 v16, v248, v249
    v_cvt_pk_bf16_f32 v17, v250, v251
    v_cvt_pk_bf16_f32 v18, v252, v253
    v_cvt_pk_bf16_f32 v19, v254, v255
    s_nop 1
    v_mfma_f32_32x32x16_bf16 v[20:35], v[12:15], v[96:99], 0
    v_mfma_f32_32x32x16_bf16 v[20:35], v[16:19], v[100:103], v[20:35]
    s_add_u32 s48, s48, 4096
    buffer_load_dwordx4 v[192:195], v3, s[20:23], s48 offen offset:0
    buffer_load_dwordx4 v[196:199], v3, s[20:23], s48 offen offset:1024
    buffer_load_dwordx4 v[200:203], v3, s[20:23], s48 offen offset:2048
    buffer_load_dwordx4 v[204:207], v3, s[20:23], s48 offen offset:3072
    v_add_u32 v1, 5, v4
    v_and_b32 v1, 7, v1
    v_lshlrev_b32 v1, 4, v1
    v_xor_b32 v1, v1, v5
    v_add_u32 v1, v1, v6
    v_xor_b32 v60, 16, v1
    v_xor_b32 v61, 64, v1
    v_xor_b32 v62, 80, v1
    s_waitcnt vmcnt(30)
    ds_read_b128 v[240:243], v1 offset:10880
    ds_read_b128 v[244:247], v60 offset:10880
    ds_read_b128 v[248:251], v61 offset:10880
    ds_read_b128 v[252:255], v62 offset:10880
    v_add_f32 v11, 0x358637bd, v44
    v_rcp_f32 v11, v11
    s_nop 0
    v_mul_f32 v36, v36, v11
    v_mul_f32 v37, v37, v11
    v_mul_f32 v38, v38, v11
    v_mul_f32 v39, v39, v11
    v_mul_f32 v40, v40, v11
    v_mul_f32 v41, v41, v11
    v_mul_f32 v42, v42, v11
    v_mul_f32 v43, v43, v11
    v_cvt_pk_bf16_f32 v44, v36, v37
    v_cvt_pk_bf16_f32 v45, v38, v39
    v_cvt_pk_bf16_f32 v46, v40, v41
    v_cvt_pk_bf16_f32 v47, v42, v43
    ds_write_b128 v10, v[44:47] offset:3072
    s_waitcnt lgkmcnt(1)
    v_cvt_pk_bf16_f32 v12, v240, v241
    v_cvt_pk_bf16_f32 v13, v242, v243
    v_cvt_pk_bf16_f32 v14, v244, v245
    v_cvt_pk_bf16_f32 v15, v246, v247
    v_cvt_pk_bf16_f32 v16, v248, v249
    v_cvt_pk_bf16_f32 v17, v250, v251
    v_cvt_pk_bf16_f32 v18, v252, v253
    v_cvt_pk_bf16_f32 v19, v254, v255
    s_nop 1
    v_mfma_f32_32x32x16_bf16 v[36:51], v[12:15], v[104:107], 0
    v_mfma_f32_32x32x16_bf16 v[36:51], v[16:19], v[108:111], v[36:51]
    s_add_u32 s48, s48, 4096
    buffer_load_dwordx4 v[208:211], v3, s[20:23], s48 offen offset:0
    buffer_load_dwordx4 v[212:215], v3, s[20:23], s48 offen offset:1024
    buffer_load_dwordx4 v[216:219], v3, s[20:23], s48 offen offset:2048
    buffer_load_dwordx4 v[220:223], v3, s[20:23], s48 offen offset:3072
    v_add_u32 v1, 6, v4
    v_and_b32 v1, 7, v1
    v_lshlrev_b32 v1, 4, v1
    v_xor_b32 v1, v1, v5
    v_add_u32 v1, v1, v6
    v_xor_b32 v60, 16, v1
    v_xor_b32 v61, 64, v1
    v_xor_b32 v62, 80, v1
    s_waitcnt vmcnt(30)
    ds_read_b128 v[240:243], v1 offset:13056
    ds_read_b128 v[244:247], v60 offset:13056
    ds_read_b128 v[248:251], v61 offset:13056
    ds_read_b128 v[252:255], v62 offset:13056
    v_add_f32 v11, 0x358637bd, v28
    v_rcp_f32 v11, v11
    s_nop 0
    v_mul_f32 v20, v20, v11
    v_mul_f32 v21, v21, v11
    v_mul_f32 v22, v22, v11
    v_mul_f32 v23, v23, v11
    v_mul_f32 v24, v24, v11
    v_mul_f32 v25, v25, v11
    v_mul_f32 v26, v26, v11
    v_mul_f32 v27, v27, v11
    v_cvt_pk_bf16_f32 v28, v20, v21
    v_cvt_pk_bf16_f32 v29, v22, v23
    v_cvt_pk_bf16_f32 v30, v24, v25
    v_cvt_pk_bf16_f32 v31, v26, v27
    ds_write_b128 v10, v[28:31] offset:4096
    s_waitcnt lgkmcnt(1)
    v_cvt_pk_bf16_f32 v12, v240, v241
    v_cvt_pk_bf16_f32 v13, v242, v243
    v_cvt_pk_bf16_f32 v14, v244, v245
    v_cvt_pk_bf16_f32 v15, v246, v247
    v_cvt_pk_bf16_f32 v16, v248, v249
    v_cvt_pk_bf16_f32 v17, v250, v251
    v_cvt_pk_bf16_f32 v18, v252, v253
    v_cvt_pk_bf16_f32 v19, v254, v255
    s_nop 1
    v_mfma_f32_32x32x16_bf16 v[20:35], v[12:15], v[112:115], 0
    v_mfma_f32_32x32x16_bf16 v[20:35], v[16:19], v[116:119], v[20:35]
    s_add_u32 s48, s48, 4096
    buffer_load_dwordx4 v[224:227], v3, s[20:23], s48 offen offset:0
    buffer_load_dwordx4 v[228:231], v3, s[20:23], s48 offen offset:1024
    buffer_load_dwordx4 v[232:235], v3, s[20:23], s48 offen offset:2048
    buffer_load_dwordx4 v[236:239], v3, s[20:23], s48 offen offset:3072
    v_add_u32 v1, 7, v4
    v_and_b32 v1, 7, v1
    v_lshlrev_b32 v1, 4, v1
    v_xor_b32 v1, v1, v5
    v_add_u32 v1, v1, v6
    v_xor_b32 v60, 16, v1
    v_xor_b32 v61, 64, v1
    v_xor_b32 v62, 80, v1
    s_waitcnt vmcnt(30)
    ds_read_b128 v[240:243], v1 offset:15232
    ds_read_b128 v[244:247], v60 offset:15232
    ds_read_b128 v[248:251], v61 offset:15232
    ds_read_b128 v[252:255], v62 offset:15232
    v_add_f32 v11, 0x358637bd, v44
    v_rcp_f32 v11, v11
    s_nop 0
    v_mul_f32 v36, v36, v11
    v_mul_f32 v37, v37, v11
    v_mul_f32 v38, v38, v11
    v_mul_f32 v39, v39, v11
    v_mul_f32 v40, v40, v11
    v_mul_f32 v41, v41, v11
    v_mul_f32 v42, v42, v11
    v_mul_f32 v43, v43, v11
    v_cvt_pk_bf16_f32 v44, v36, v37
    v_cvt_pk_bf16_f32 v45, v38, v39
    v_cvt_pk_bf16_f32 v46, v40, v41
    v_cvt_pk_bf16_f32 v47, v42, v43
    ds_write_b128 v10, v[44:47] offset:5120
    s_waitcnt lgkmcnt(1)
    v_cvt_pk_bf16_f32 v12, v240, v241
    v_cvt_pk_bf16_f32 v13, v242, v243
    v_cvt_pk_bf16_f32 v14, v244, v245
    v_cvt_pk_bf16_f32 v15, v246, v247
    v_cvt_pk_bf16_f32 v16, v248, v249
    v_cvt_pk_bf16_f32 v17, v250, v251
    v_cvt_pk_bf16_f32 v18, v252, v253
    v_cvt_pk_bf16_f32 v19, v254, v255
    s_nop 1
    v_mfma_f32_32x32x16_bf16 v[36:51], v[12:15], v[120:123], 0
    v_mfma_f32_32x32x16_bf16 v[36:51], v[16:19], v[124:127], v[36:51]
    s_add_u32 s48, s48, 4096
    buffer_load_dwordx4 v[240:243], v3, s[20:23], s48 offen offset:0
    buffer_load_dwordx4 v[244:247], v3, s[20:23], s48 offen offset:1024
    buffer_load_dwordx4 v[248:251], v3, s[20:23], s48 offen offset:2048
    buffer_load_dwordx4 v[252:255], v3, s[20:23], s48 offen offset:3072
    v_add_f32 v11, 0x358637bd, v28
    v_rcp_f32 v11, v11
    s_nop 0
    v_mul_f32 v20, v20, v11
    v_mul_f32 v21, v21, v11
    v_mul_f32 v22, v22, v11
    v_mul_f32 v23, v23, v11
    v_mul_f32 v24, v24, v11
    v_mul_f32 v25, v25, v11
    v_mul_f32 v26, v26, v11
    v_mul_f32 v27, v27, v11
    v_cvt_pk_bf16_f32 v28, v20, v21
    v_cvt_pk_bf16_f32 v29, v22, v23
    v_cvt_pk_bf16_f32 v30, v24, v25
    v_cvt_pk_bf16_f32 v31, v26, v27
    ds_write_b128 v10, v[28:31] offset:6144
    s_nop 7
    v_add_f32 v11, 0x358637bd, v44
    v_rcp_f32 v11, v11
    s_nop 0
    v_mul_f32 v36, v36, v11
    v_mul_f32 v37, v37, v11
    v_mul_f32 v38, v38, v11
    v_mul_f32 v39, v39, v11
    v_mul_f32 v40, v40, v11
    v_mul_f32 v41, v41, v11
    v_mul_f32 v42, v42, v11
    v_mul_f32 v43, v43, v11
    v_cvt_pk_bf16_f32 v44, v36, v37
    v_cvt_pk_bf16_f32 v45, v38, v39
    v_cvt_pk_bf16_f32 v46, v40, v41
    v_cvt_pk_bf16_f32 v47, v42, v43
    ds_write_b128 v10, v[44:47] offset:7168
    s_waitcnt lgkmcnt(0)
    s_barrier
    ds_read_b128 v[64:67], v3 offset:0
    ds_read_b128 v[68:71], v3 offset:1024
    ds_read_b128 v[72:75], v3 offset:2048
    ds_read_b128 v[76:79], v3 offset:3072
    s_waitcnt vmcnt(31)
    s_waitcnt lgkmcnt(3)
    v_mfma_f32_32x32x16_bf16 v[20:35], v[128:131], v[64:67], 0
    ds_read_b128 v[80:83], v3 offset:4096
    s_waitcnt vmcnt(30)
    s_waitcnt lgkmcnt(3)
    v_mfma_f32_32x32x16_bf16 v[20:35], v[132:135], v[68:71], v[20:35]
    ds_read_b128 v[84:87], v3 offset:5120
    s_waitcnt vmcnt(29)
    s_waitcnt lgkmcnt(3)
    v_mfma_f32_32x32x16_bf16 v[20:35], v[136:139], v[72:75], v[20:35]
    ds_read_b128 v[64:67], v3 offset:6144
    s_waitcnt vmcnt(28)
    s_waitcnt lgkmcnt(3)
    v_mfma_f32_32x32x16_bf16 v[20:35], v[140:143], v[76:79], v[20:35]
    ds_read_b128 v[68:71], v3 offset:7168
    s_waitcnt vmcnt(27)
    s_waitcnt lgkmcnt(3)
    v_mfma_f32_32x32x16_bf16 v[20:35], v[144:147], v[80:83], v[20:35]
    ds_read_b128 v[72:75], v3 offset:8192
    s_waitcnt vmcnt(26)
    s_waitcnt lgkmcnt(3)
    v_mfma_f32_32x32x16_bf16 v[20:35], v[148:151], v[84:87], v[20:35]
    ds_read_b128 v[76:79], v3 offset:9216
    s_waitcnt vmcnt(25)
    s_waitcnt lgkmcnt(3)
    v_mfma_f32_32x32x16_bf16 v[20:35], v[152:155], v[64:67], v[20:35]
    ds_read_b128 v[80:83], v3 offset:10240
    s_waitcnt vmcnt(24)
    s_waitcnt lgkmcnt(3)
    v_mfma_f32_32x32x16_bf16 v[20:35], v[156:159], v[68:71], v[20:35]
    ds_read_b128 v[84:87], v3 offset:11264
    s_waitcnt vmcnt(23)
    s_waitcnt lgkmcnt(3)
    v_mfma_f32_32x32x16_bf16 v[20:35], v[160:163], v[72:75], v[20:35]
    ds_read_b128 v[64:67], v3 offset:12288
    s_waitcnt vmcnt(22)
    s_waitcnt lgkmcnt(3)
    v_mfma_f32_32x32x16_bf16 v[20:35], v[164:167], v[76:79], v[20:35]
    ds_read_b128 v[68:71], v3 offset:13312
    s_waitcnt vmcnt(21)
    s_waitcnt lgkmcnt(3)
    v_mfma_f32_32x32x16_bf16 v[20:35], v[168:171], v[80:83], v[20:35]
    ds_read_b128 v[72:75], v3 offset:14336
    s_waitcnt vmcnt(20)
    s_waitcnt lgkmcnt(3)
    v_mfma_f32_32x32x16_bf16 v[20:35], v[172:175], v[84:87], v[20:35]
    ds_read_b128 v[76:79], v3 offset:15360
    s_waitcnt vmcnt(19)
    s_waitcnt lgkmcnt(3)
    v_mfma_f32_32x32x16_bf16 v[20:35], v[176:179], v[64:67], v[20:35]
    ds_read_b128 v[80:83], v3 offset:16384
    s_waitcnt vmcnt(18)
    s_waitcnt lgkmcnt(3)
    v_mfma_f32_32x32x16_bf16 v[20:35], v[180:183], v[68:71], v[20:35]
    ds_read_b128 v[84:87], v3 offset:17408
    s_waitcnt vmcnt(17)
    s_waitcnt lgkmcnt(3)
    v_mfma_f32_32x32x16_bf16 v[20:35], v[184:187], v[72:75], v[20:35]
    ds_read_b128 v[64:67], v3 offset:18432
    s_waitcnt vmcnt(16)
    s_waitcnt lgkmcnt(3)
    v_mfma_f32_32x32x16_bf16 v[20:35], v[188:191], v[76:79], v[20:35]
    ds_read_b128 v[68:71], v3 offset:19456
    s_waitcnt vmcnt(15)
    s_waitcnt lgkmcnt(3)
    v_mfma_f32_32x32x16_bf16 v[20:35], v[192:195], v[80:83], v[20:35]
    ds_read_b128 v[72:75], v3 offset:20480
    s_waitcnt vmcnt(14)
    s_waitcnt lgkmcnt(3)
    v_mfma_f32_32x32x16_bf16 v[20:35], v[196:199], v[84:87], v[20:35]
    ds_read_b128 v[76:79], v3 offset:21504
    s_waitcnt vmcnt(13)
    s_waitcnt lgkmcnt(3)
    v_mfma_f32_32x32x16_bf16 v[20:35], v[200:203], v[64:67], v[20:35]
    ds_read_b128 v[80:83], v3 offset:22528
    s_waitcnt vmcnt(12)
    s_waitcnt lgkmcnt(3)
    v_mfma_f32_32x32x16_bf16 v[20:35], v[204:207], v[68:71], v[20:35]
    ds_read_b128 v[84:87], v3 offset:23552
    s_waitcnt vmcnt(11)
    s_waitcnt lgkmcnt(3)
    v_mfma_f32_32x32x16_bf16 v[20:35], v[208:211], v[72:75], v[20:35]
    ds_read_b128 v[64:67], v3 offset:24576
    s_waitcnt vmcnt(10)
    s_waitcnt lgkmcnt(3)
    v_mfma_f32_32x32x16_bf16 v[20:35], v[212:215], v[76:79], v[20:35]
    ds_read_b128 v[68:71], v3 offset:25600
    s_waitcnt vmcnt(9)
    s_waitcnt lgkmcnt(3)
    v_mfma_f32_32x32x16_bf16 v[20:35], v[216:219], v[80:83], v[20:35]
    ds_read_b128 v[72:75], v3 offset:26624
    s_waitcnt vmcnt(8)
    s_waitcnt lgkmcnt(3)
    v_mfma_f32_32x32x16_bf16 v[20:35], v[220:223], v[84:87], v[20:35]
    ds_read_b128 v[76:79], v3 offset:27648
    s_waitcnt vmcnt(7)
    s_waitcnt lgkmcnt(3)
    v_mfma_f32_32x32x16_bf16 v[20:35], v[224:227], v[64:67], v[20:35]
    ds_read_b128 v[80:83], v3 offset:28672
    s_waitcnt vmcnt(6)
    s_waitcnt lgkmcnt(3)
    v_mfma_f32_32x32x16_bf16 v[20:35], v[228:231], v[68:71], v[20:35]
    ds_read_b128 v[84:87], v3 offset:29696
    s_waitcnt vmcnt(5)
    s_waitcnt lgkmcnt(3)
    v_mfma_f32_32x32x16_bf16 v[20:35], v[232:235], v[72:75], v[20:35]
    ds_read_b128 v[64:67], v3 offset:30720
    s_waitcnt vmcnt(4)
    s_waitcnt lgkmcnt(3)
    v_mfma_f32_32x32x16_bf16 v[20:35], v[236:239], v[76:79], v[20:35]
    ds_read_b128 v[68:71], v3 offset:31744
    s_waitcnt vmcnt(3)
    s_waitcnt lgkmcnt(3)
    v_mfma_f32_32x32x16_bf16 v[20:35], v[240:243], v[80:83], v[20:35]
    s_waitcnt vmcnt(2)
    s_waitcnt lgkmcnt(2)
    v_mfma_f32_32x32x16_bf16 v[20:35], v[244:247], v[84:87], v[20:35]
    s_waitcnt vmcnt(1)
    s_waitcnt lgkmcnt(1)
    v_mfma_f32_32x32x16_bf16 v[20:35], v[248:251], v[64:67], v[20:35]
    s_waitcnt vmcnt(0)
    s_waitcnt lgkmcnt(0)
    v_mfma_f32_32x32x16_bf16 v[20:35], v[252:255], v[68:71], v[20:35]
    s_mov_b32 s54, 0xffff0000
    v_lshlrev_b32 v64, 16, v52
    v_and_b32 v65, s54, v52
    v_lshlrev_b32 v66, 16, v53
    v_and_b32 v67, s54, v53
    v_lshlrev_b32 v68, 16, v54
    v_and_b32 v69, s54, v54
    v_lshlrev_b32 v70, 16, v55
    v_and_b32 v71, s54, v55
    v_lshlrev_b32 v72, 16, v56
    v_and_b32 v73, s54, v56
    v_lshlrev_b32 v74, 16, v57
    v_and_b32 v75, s54, v57
    v_lshlrev_b32 v76, 16, v58
    v_and_b32 v77, s54, v58
    v_lshlrev_b32 v78, 16, v59
    v_and_b32 v79, s54, v59
    v_add_f32 v64, v64, v20
    v_add_f32 v65, v65, v21
    v_add_f32 v66, v66, v22
    v_add_f32 v67, v67, v23
    v_add_f32 v68, v68, v24
    v_add_f32 v69, v69, v25
    v_add_f32 v70, v70, v26
    v_add_f32 v71, v71, v27
    v_add_f32 v72, v72, v28
    v_add_f32 v73, v73, v29
    v_add_f32 v74, v74, v30
    v_add_f32 v75, v75, v31
    v_add_f32 v76, v76, v32
    v_add_f32 v77, v77, v33
    v_add_f32 v78, v78, v34
    v_add_f32 v79, v79, v35
    v_cvt_pk_bf16_f32 v80, v64, v65
    v_cvt_pk_bf16_f32 v81, v66, v67
    v_cvt_pk_bf16_f32 v82, v68, v69
    v_cvt_pk_bf16_f32 v83, v70, v71
    v_cvt_pk_bf16_f32 v84, v72, v73
    v_cvt_pk_bf16_f32 v85, v74, v75
    v_cvt_pk_bf16_f32 v86, v76, v77
    v_cvt_pk_bf16_f32 v87, v78, v79
    buffer_store_dwordx4 v[80:83], v9, s[24:27], s49 offen sc1
    buffer_store_dwordx4 v[84:87], v9, s[24:27], s49 offen offset:16 sc1
K6_DONE:
    s_endpgm
.section .rodata,"a"
.p2align 6
.amdhsa_kernel interleave_layers__ssm_conv_h3__linear_kernel_hedgehog__prompt_kernel
  .amdhsa_next_free_vgpr 128
  .amdhsa_next_free_sgpr 96
  .amdhsa_accum_offset 128
  .amdhsa_group_segment_fixed_size 0
  .amdhsa_kernarg_size 104
  .amdhsa_user_sgpr_count 2
  .amdhsa_user_sgpr_kernarg_segment_ptr 1
  .amdhsa_system_sgpr_workgroup_id_x 1
.end_amdhsa_kernel
.p2align 6
.amdhsa_kernel conv_kernel
  .amdhsa_next_free_vgpr 248
  .amdhsa_next_free_sgpr 96
  .amdhsa_accum_offset 248
  .amdhsa_group_segment_fixed_size 0
  .amdhsa_kernarg_size 104
  .amdhsa_user_sgpr_count 2
  .amdhsa_user_sgpr_kernarg_segment_ptr 1
  .amdhsa_system_sgpr_workgroup_id_x 1
.end_amdhsa_kernel
.p2align 6
.amdhsa_kernel qkv1_kernel
  .amdhsa_next_free_vgpr 256
  .amdhsa_next_free_sgpr 96
  .amdhsa_accum_offset 256
  .amdhsa_group_segment_fixed_size 0
  .amdhsa_kernarg_size 104
  .amdhsa_user_sgpr_count 2
  .amdhsa_user_sgpr_kernarg_segment_ptr 1
  .amdhsa_system_sgpr_workgroup_id_x 1
.end_amdhsa_kernel
.p2align 6
.amdhsa_kernel proj1_kernel
  .amdhsa_next_free_vgpr 256
  .amdhsa_next_free_sgpr 96
  .amdhsa_accum_offset 256
  .amdhsa_group_segment_fixed_size 0
  .amdhsa_kernarg_size 104
  .amdhsa_user_sgpr_count 2
  .amdhsa_user_sgpr_kernarg_segment_ptr 1
  .amdhsa_system_sgpr_workgroup_id_x 1
.end_amdhsa_kernel
.p2align 6
.amdhsa_kernel qkv2_kernel
  .amdhsa_next_free_vgpr 256
  .amdhsa_next_free_sgpr 96
  .amdhsa_accum_offset 256
  .amdhsa_group_segment_fixed_size 0
  .amdhsa_kernarg_size 104
  .amdhsa_user_sgpr_count 2
  .amdhsa_user_sgpr_kernarg_segment_ptr 1
  .amdhsa_system_sgpr_workgroup_id_x 1
.end_amdhsa_kernel
.p2align 6
.amdhsa_kernel proj2_kernel
  .amdhsa_next_free_vgpr 256
  .amdhsa_next_free_sgpr 96
  .amdhsa_accum_offset 256
  .amdhsa_group_segment_fixed_size 0
  .amdhsa_kernarg_size 104
  .amdhsa_user_sgpr_count 2
  .amdhsa_user_sgpr_kernarg_segment_ptr 1
  .amdhsa_system_sgpr_workgroup_id_x 1
.end_amdhsa_kernel
```
